```python
import torch

def _softmax(x, axis=-1):
    return torch.softmax(x, dim=axis)
def _gelu(x):
    return torch.nn.functional.gelu(x, approximate="tanh")
def _silu(x):
    return torch.nn.functional.silu(x)
def _sigmoid(x):
    return torch.sigmoid(x)
def _layernorm(x, axis=-1, eps=1e-5):
    m = x.mean(dim=axis, keepdim=True)
    v = x.var(dim=axis, keepdim=True, unbiased=False)
    return (x - m) / torch.sqrt(v + eps)
def _scatter_add(tgt, idx, src, axis=0):
    return tgt.clone().index_add_(axis, idx, src)
def _segment_sum(src, seg, n):
    out = torch.zeros((n,) + src.shape[1:], dtype=src.dtype)
    return out.index_add_(0, seg, src)
def _pad(x, pw):
    flat = tuple(v for pair in reversed(pw) for v in pair)
    return torch.nn.functional.pad(x, flat)

kernel_name = 'standalone__mha_softmax__near_ridge'

def setup_inputs():

    _w = (lambda a: (lambda t: t.to(torch.bfloat16) if t.is_floating_point() else t)(torch.as_tensor(a)))
    B, H, Sq, Sk, D = 8, 16, 304, 1024, 256
    return {
        "q": _w((lambda *s: torch.randn(*s, dtype=torch.bfloat16) * 0.8)(B, H, Sq, D)),
        "k": _w((lambda *s: torch.randn(*s, dtype=torch.bfloat16) * 0.8)(B, H, Sk, D)),
        "v": _w((lambda *s: torch.randn(*s, dtype=torch.bfloat16) * 0.05)(B, H, Sk, D)),
    }

def reference(q, k, v):
    scale = q.shape[-1] ** -0.5
    scores = torch.einsum("bhqd,bhkd->bhqk", q, k) * scale
    p = _softmax(scores, axis=-1)
    return torch.einsum("bhqk,bhkd->bhqd", p, v)
```

```asm
; @launch grid=(256,1,1) block=(256,1,1) lds=163840
.amdgcn_target "amdgcn-amd-amdhsa--gfx950"
.text
.globl standalone__mha_softmax__near_ridge_kernel
.p2align 8
.type standalone__mha_softmax__near_ridge_kernel,@function
standalone__mha_softmax__near_ridge_kernel:
    s_cmp_ge_u32 s2, 256
    s_cbranch_scc1 L_done
    s_load_dwordx4 s[4:7], s[0:1], 0
    s_load_dwordx4 s[36:39], s[0:1], 16
    v_and_b32 v236, 63, v0
    v_lshrrev_b32 v1, 6, v0
    s_and_b32 s34, s2, 7
    s_lshr_b32 s35, s2, 3
    v_readfirstlane_b32 s30, v1
    s_and_b32 s33, s35, 1
    s_lshr_b32 s35, s35, 1
    s_lshl_b32 s35, s35, 3
    s_add_u32 s40, s35, s34
    s_lshr_b32 s31, s30, 1
    s_and_b32 s32, s30, 1
    s_lshl_b32 s25, s30, 12
    v_lshrrev_b32 v6, 5, v236
    v_and_b32 v7, 31, v236
    s_lshl_b32 s34, s30, 3
    v_add_u32 v3, s34, v6
    v_lshlrev_b32 v8, 9, v3
    v_add_u32 v4, 0, v3
    v_and_b32 v4, 15, v4
    v_xor_b32 v4, v4, v7
    v_lshl_add_u32 v228, v4, 4, v8
    v_add_u32 v4, 2, v3
    v_and_b32 v4, 15, v4
    v_xor_b32 v4, v4, v7
    v_lshl_add_u32 v229, v4, 4, v8
    v_add_u32 v4, 4, v3
    v_and_b32 v4, 15, v4
    v_xor_b32 v4, v4, v7
    v_lshl_add_u32 v230, v4, 4, v8
    v_add_u32 v4, 6, v3
    v_and_b32 v4, 15, v4
    v_xor_b32 v4, v4, v7
    v_lshl_add_u32 v231, v4, 4, v8
    s_waitcnt lgkmcnt(0)
    s_mul_i32 s41, s33, 81920
    s_lshr_b32 s42, s40, 3
    s_mul_i32 s42, s42, 16384
    s_and_b32 s42, s42, 0x7ffff
    s_lshl_b32 s34, s40, 19
    s_add_u32 s12, s6, s34
    s_addc_u32 s13, s7, 0
    s_mov_b32 s14, 524288
    s_mov_b32 s15, 0x20000
    s_mul_i32 s35, s40, 155648
    s_mov_b32 s26, s42
    s_add_u32 m0, s25, 0
    s_add_u32 s8, s4, s35
    s_addc_u32 s9, s5, 0
    s_mov_b32 s10, 155648
    s_mov_b32 s11, 0x20000
    buffer_load_dwordx4 v228, s[12:15], s26 offen offset:0 nt lds
    buffer_load_dwordx4 v229, s[12:15], s26 offen offset:1024 nt lds
    buffer_load_dwordx4 v230, s[12:15], s26 offen offset:2048 nt lds
    buffer_load_dwordx4 v231, s[12:15], s26 offen offset:3072 nt lds
    s_add_u32 s26, s26, 16384
    s_and_b32 s26, s26, 0x7ffff
    s_getpc_b64 s[46:47]
L_pcref:
    s_cmp_lg_u32 s30, 3
    s_cbranch_scc1 L_nopf
    s_lshr_b32 s48, s2, 3
    s_mul_i32 s48, s48, 1280
    v_lshlrev_b32 v10, 7, v236
    v_add_u32 v9, s48, v10
    v_cmp_gt_u32 vcc, 1280, v10
    s_mov_b32 s48, L_codeend-L_pcref
    v_cmp_gt_u32 s[44:45], s48, v9
    s_nop 1
    s_and_b64 vcc, vcc, s[44:45]
    s_and_saveexec_b64 s[44:45], vcc
    s_cbranch_execz L_pfdone
    global_load_dword v255, v9, s[46:47]
L_pfdone:
    s_mov_b64 exec, s[44:45]
L_nopf:
    s_add_u32 m0, s25, 131072
    s_nop 0
    buffer_load_dwordx4 v228, s[8:11], s41 offen offset:0 nt lds
    buffer_load_dwordx4 v229, s[8:11], s41 offen offset:1024 nt lds
    buffer_load_dwordx4 v230, s[8:11], s41 offen offset:2048 nt lds
    buffer_load_dwordx4 v231, s[8:11], s41 offen offset:3072 nt lds
    s_add_u32 s41, s41, 16384
    s_add_u32 m0, s25, 147456
    s_nop 0
    buffer_load_dwordx4 v228, s[8:11], s41 offen offset:0 nt lds
    buffer_load_dwordx4 v229, s[8:11], s41 offen offset:1024 nt lds
    buffer_load_dwordx4 v230, s[8:11], s41 offen offset:2048 nt lds
    buffer_load_dwordx4 v231, s[8:11], s41 offen offset:3072 nt lds
    s_add_u32 s41, s41, 16384
    s_add_u32 m0, s25, 49152
    s_nop 0
    buffer_load_dwordx4 v228, s[8:11], s41 offen offset:0 nt lds
    buffer_load_dwordx4 v229, s[8:11], s41 offen offset:1024 nt lds
    buffer_load_dwordx4 v230, s[8:11], s41 offen offset:2048 nt lds
    buffer_load_dwordx4 v231, s[8:11], s41 offen offset:3072 nt lds
    s_add_u32 s41, s41, 16384
    s_add_u32 m0, s25, 98304
    s_nop 0
    buffer_load_dwordx4 v228, s[8:11], s41 offen offset:0 nt lds
    buffer_load_dwordx4 v229, s[8:11], s41 offen offset:1024 nt lds
    buffer_load_dwordx4 v230, s[8:11], s41 offen offset:2048 nt lds
    buffer_load_dwordx4 v231, s[8:11], s41 offen offset:3072 nt lds
    s_add_u32 s41, s41, 16384
    s_add_u32 m0, s25, 114688
    s_nop 0
    buffer_load_dwordx4 v228, s[8:11], s41 offen offset:0 nt lds
    buffer_load_dwordx4 v229, s[8:11], s41 offen offset:1024 nt lds
    buffer_load_dwordx4 v230, s[8:11], s41 offen offset:2048 nt lds
    buffer_load_dwordx4 v231, s[8:11], s41 offen offset:3072 nt lds
    s_add_u32 s41, s41, 16384
    s_add_u32 s16, s36, s34
    s_addc_u32 s17, s37, 0
    s_mov_b32 s18, 524288
    s_mov_b32 s19, 0x20000
    s_add_u32 s20, s38, s35
    s_addc_u32 s21, s39, 0
    s_mov_b32 s22, 155648
    s_mov_b32 s23, 0x20000
    s_mov_b32 s27, s42
    s_and_b32 s34, s33, s31
    s_cmp_lg_u32 s34, 0
    s_cbranch_scc1 L_path4
    s_mov_b32 s24, 0x3db8aa3b
    s_mov_b32 s29, 0
    s_mov_b32 s44, 0
    s_mov_b32 s45, 16384
    s_mov_b32 s46, 32768
    s_mov_b32 s47, 49152
    s_mov_b32 s48, 65536
    v_and_b32 v251, 15, v236
    v_lshrrev_b32 v252, 4, v236
    s_lshl_b32 s34, s32, 13
    v_lshlrev_b32 v253, 9, v251
    v_add_u32 v253, s34, v253
    v_add_u32 v254, 0, v252
    v_xor_b32 v254, v254, v251
    v_lshl_add_u32 v214, v254, 4, v253
    v_add_u32 v254, 4, v252
    v_xor_b32 v254, v254, v251
    v_lshl_add_u32 v215, v254, 4, v253
    v_add_u32 v254, 8, v252
    v_xor_b32 v254, v254, v251
    v_lshl_add_u32 v216, v254, 4, v253
    v_add_u32 v254, 12, v252
    v_xor_b32 v254, v254, v251
    v_lshl_add_u32 v217, v254, 4, v253
    v_lshrrev_b32 v6, 5, v236
    v_and_b32 v7, 31, v236
    s_lshl_b32 s34, s30, 3
    v_add_u32 v3, s34, v6
    v_lshlrev_b32 v8, 9, v3
    v_add_u32 v4, 0, v6
    v_lshlrev_b32 v4, 1, v4
    v_xor_b32 v4, v4, v7
    v_lshl_add_u32 v232, v4, 4, v8
    v_add_u32 v4, 2, v6
    v_lshlrev_b32 v4, 1, v4
    v_xor_b32 v4, v4, v7
    v_lshl_add_u32 v233, v4, 4, v8
    v_add_u32 v4, 4, v6
    v_lshlrev_b32 v4, 1, v4
    v_xor_b32 v4, v4, v7
    v_lshl_add_u32 v234, v4, 4, v8
    v_add_u32 v4, 6, v6
    v_lshlrev_b32 v4, 1, v4
    v_xor_b32 v4, v4, v7
    v_lshl_add_u32 v235, v4, 4, v8
    v_and_b32 v1, 15, v236
    v_lshrrev_b32 v2, 4, v236
    s_sub_u32 s34, s31, s32
    s_lshl_b32 s34, s34, 13
    v_add_u32 v238, s34, v214
    v_add_u32 v239, s34, v215
    v_add_u32 v240, s34, v216
    v_add_u32 v241, s34, v217
    s_mul_i32 s34, s33, 160
    s_lshl_b32 s35, s31, 4
    s_add_u32 s34, s34, s35
    v_add_u32 v3, s34, v2
    v_lshlrev_b32 v3, 9, v3
    v_lshl_add_u32 v3, v1, 4, v3
    s_lshl_b32 s35, s32, 8
    v_add_u32 v249, s35, v3
    v_add_u32 v250, 4096, v249
    v_lshrrev_b32 v6, 2, v1
    v_and_b32 v7, 3, v1
    v_and_b32 v8, 1, v2
    v_lshlrev_b32 v8, 2, v8
    v_add_u32 v8, v8, v6
    v_lshlrev_b32 v3, 2, v2
    v_add_u32 v3, v3, v6
    v_lshlrev_b32 v3, 9, v3
    v_lshrrev_b32 v4, 1, v7
    v_lshlrev_b32 v4, 4, v4
    v_and_b32 v5, 1, v7
    v_lshlrev_b32 v5, 3, v5
    v_add3_u32 v3, v3, v4, v5
    s_lshl_b32 s34, s32, 8
    s_add_u32 s34, s34, 65536
    v_add_u32 v3, s34, v3
    v_xor_b32 v4, 0, v8
    v_lshl_add_u32 v218, v4, 5, v3
    v_xor_b32 v4, 1, v8
    v_lshl_add_u32 v219, v4, 5, v3
    v_xor_b32 v4, 2, v8
    v_lshl_add_u32 v220, v4, 5, v3
    v_xor_b32 v4, 3, v8
    v_lshl_add_u32 v221, v4, 5, v3
    v_xor_b32 v4, 4, v8
    v_lshl_add_u32 v222, v4, 5, v3
    v_xor_b32 v4, 5, v8
    v_lshl_add_u32 v223, v4, 5, v3
    v_xor_b32 v4, 6, v8
    v_lshl_add_u32 v224, v4, 5, v3
    v_xor_b32 v4, 7, v8
    v_lshl_add_u32 v225, v4, 5, v3
    s_mul_i32 s34, s31, 5120
    s_add_u32 s34, s34, 131072
    v_lshlrev_b32 v3, 4, v236
    v_add_u32 v227, s34, v3
    s_lshl_b32 s35, s32, 3
    v_add_u32 v226, s35, v227
    v_lshlrev_b32 v3, 2, v236
    s_mul_i32 s34, s30, 1280
    s_add_u32 s34, s34, 151552
    v_add_u32 v237, s34, v3
    s_xor_b32 s35, s30, 1
    s_mul_i32 s34, s35, 1280
    s_add_u32 s34, s34, 151552
    v_add_u32 v248, s34, v3
    v_subrev_u32 v246, 151552, v237
    v_subrev_u32 v247, 151552, v248
    v_mov_b32 v0, 0
    v_mov_b32 v1, 0
    v_mov_b32 v2, 0
    v_mov_b32 v3, 0
    v_mov_b32 v4, 0
    v_mov_b32 v5, 0
    v_mov_b32 v6, 0
    v_mov_b32 v7, 0
    v_mov_b32 v8, 0
    v_mov_b32 v9, 0
    v_mov_b32 v10, 0
    v_mov_b32 v11, 0
    v_mov_b32 v12, 0
    v_mov_b32 v13, 0
    v_mov_b32 v14, 0
    v_mov_b32 v15, 0
    v_mov_b32 v16, 0
    v_mov_b32 v17, 0
    v_mov_b32 v18, 0
    v_mov_b32 v19, 0
    v_mov_b32 v20, 0
    v_mov_b32 v21, 0
    v_mov_b32 v22, 0
    v_mov_b32 v23, 0
    v_mov_b32 v24, 0
    v_mov_b32 v25, 0
    v_mov_b32 v26, 0
    v_mov_b32 v27, 0
    v_mov_b32 v28, 0
    v_mov_b32 v29, 0
    v_mov_b32 v30, 0
    v_mov_b32 v31, 0
    v_mov_b32 v32, 0
    v_mov_b32 v33, 0
    v_mov_b32 v34, 0
    v_mov_b32 v35, 0
    v_mov_b32 v36, 0
    v_mov_b32 v37, 0
    v_mov_b32 v38, 0
    v_mov_b32 v39, 0
    v_mov_b32 v40, 0
    v_mov_b32 v41, 0
    v_mov_b32 v42, 0
    v_mov_b32 v43, 0
    v_mov_b32 v44, 0
    v_mov_b32 v45, 0
    v_mov_b32 v46, 0
    v_mov_b32 v47, 0
    v_mov_b32 v48, 0
    v_mov_b32 v49, 0
    v_mov_b32 v50, 0
    v_mov_b32 v51, 0
    v_mov_b32 v52, 0
    v_mov_b32 v53, 0
    v_mov_b32 v54, 0
    v_mov_b32 v55, 0
    v_mov_b32 v56, 0
    v_mov_b32 v57, 0
    v_mov_b32 v58, 0
    v_mov_b32 v59, 0
    v_mov_b32 v60, 0
    v_mov_b32 v61, 0
    v_mov_b32 v62, 0
    v_mov_b32 v63, 0
    v_mov_b32 v64, 0
    v_mov_b32 v65, 0
    v_mov_b32 v66, 0
    v_mov_b32 v67, 0
    v_mov_b32 v68, 0
    v_mov_b32 v69, 0
    v_mov_b32 v70, 0
    v_mov_b32 v71, 0
    v_mov_b32 v72, 0
    v_mov_b32 v73, 0
    v_mov_b32 v74, 0
    v_mov_b32 v75, 0
    v_mov_b32 v76, 0
    v_mov_b32 v77, 0
    v_mov_b32 v78, 0
    v_mov_b32 v79, 0
    v_mov_b32 v80, 0
    v_mov_b32 v81, 0
    v_mov_b32 v82, 0
    v_mov_b32 v83, 0
    v_mov_b32 v84, 0
    v_mov_b32 v85, 0
    v_mov_b32 v86, 0
    v_mov_b32 v87, 0
    v_mov_b32 v88, 0
    v_mov_b32 v89, 0
    v_mov_b32 v90, 0
    v_mov_b32 v91, 0
    v_mov_b32 v92, 0
    v_mov_b32 v93, 0
    v_mov_b32 v94, 0
    v_mov_b32 v95, 0
    v_mov_b32 v96, 0
    v_mov_b32 v97, 0
    v_mov_b32 v98, 0
    v_mov_b32 v99, 0
    v_mov_b32 v100, 0
    v_mov_b32 v101, 0
    v_mov_b32 v102, 0
    v_mov_b32 v103, 0
    v_mov_b32 v104, 0
    v_mov_b32 v105, 0
    v_mov_b32 v106, 0
    v_mov_b32 v107, 0
    v_mov_b32 v108, 0
    v_mov_b32 v109, 0
    v_mov_b32 v110, 0
    v_mov_b32 v111, 0
    v_mov_b32 v112, 0
    v_mov_b32 v113, 0
    v_mov_b32 v114, 0
    v_mov_b32 v115, 0
    v_mov_b32 v116, 0
    v_mov_b32 v117, 0
    v_mov_b32 v118, 0
    v_mov_b32 v119, 0
    v_mov_b32 v120, 0
    v_mov_b32 v121, 0
    v_mov_b32 v122, 0
    v_mov_b32 v123, 0
    v_mov_b32 v124, 0
    v_mov_b32 v125, 0
    v_mov_b32 v126, 0
    v_mov_b32 v127, 0
    v_mov_b32 v128, 0
    v_mov_b32 v129, 0
    v_mov_b32 v130, 0
    v_mov_b32 v131, 0
    v_mov_b32 v132, 0
    v_mov_b32 v133, 0
    v_mov_b32 v134, 0
    v_mov_b32 v135, 0
    v_mov_b32 v136, 0
    v_mov_b32 v137, 0
    v_mov_b32 v138, 0
    v_mov_b32 v139, 0
    v_mov_b32 v140, 0
    v_mov_b32 v141, 0
    v_mov_b32 v142, 0
    v_mov_b32 v143, 0
    v_mov_b32 v144, 0
    v_mov_b32 v145, 0
    v_mov_b32 v146, 0
    v_mov_b32 v147, 0
    v_mov_b32 v148, 0
    v_mov_b32 v149, 0
    v_mov_b32 v150, 0
    v_mov_b32 v151, 0
    v_mov_b32 v152, 0
    v_mov_b32 v153, 0
    v_mov_b32 v154, 0
    v_mov_b32 v155, 0
    v_mov_b32 v156, 0
    v_mov_b32 v157, 0
    v_mov_b32 v158, 0
    v_mov_b32 v159, 0
    v_mov_b32 v204, 0
    v_mov_b32 v205, 0
    v_mov_b32 v206, 0
    v_mov_b32 v207, 0
    v_mov_b32 v208, 0
    s_waitcnt vmcnt(16)
    s_barrier
    ds_read_b128 a[160:163], v214 offset:0
    ds_read_b128 a[164:167], v215 offset:0
    ds_read_b128 a[168:171], v216 offset:0
    ds_read_b128 a[172:175], v217 offset:0
    ds_read_b128 a[176:179], v214 offset:256
    ds_read_b128 a[180:183], v215 offset:256
    ds_read_b128 a[184:187], v216 offset:256
    ds_read_b128 a[188:191], v217 offset:256
    v_add_u32 v242, 131072, v238
    v_add_u32 v243, 131072, v239
    v_add_u32 v244, 131072, v240
    v_add_u32 v245, 131072, v241
    ds_read_b128 a[0:3], v242 offset:0
    ds_read_b128 a[4:7], v243 offset:0
    ds_read_b128 a[8:11], v244 offset:0
    ds_read_b128 a[12:15], v245 offset:0
    ds_read_b128 a[16:19], v242 offset:256
    ds_read_b128 a[20:23], v243 offset:256
    ds_read_b128 a[24:27], v244 offset:256
    ds_read_b128 a[28:31], v245 offset:256
    s_add_u32 m0, s25, 16384
    s_nop 0
    buffer_load_dwordx4 v228, s[12:15], s26 offen offset:0 nt lds
    buffer_load_dwordx4 v229, s[12:15], s26 offen offset:1024 nt lds
    buffer_load_dwordx4 v230, s[12:15], s26 offen offset:2048 nt lds
    buffer_load_dwordx4 v231, s[12:15], s26 offen offset:3072 nt lds
    s_add_u32 s26, s26, 16384
    s_and_b32 s26, s26, 0x7ffff
    s_waitcnt lgkmcnt(0)
    v_mfma_f32_16x16x32_bf16 v[160:163], a[160:163], a[0:3], 0
    v_mfma_f32_16x16x32_bf16 v[160:163], a[164:167], a[4:7], v[160:163]
    v_mfma_f32_16x16x32_bf16 v[160:163], a[168:171], a[8:11], v[160:163]
    v_mfma_f32_16x16x32_bf16 v[160:163], a[172:175], a[12:15], v[160:163]
    v_mfma_f32_16x16x32_bf16 v[160:163], a[176:179], a[16:19], v[160:163]
    v_mfma_f32_16x16x32_bf16 v[160:163], a[180:183], a[20:23], v[160:163]
    v_mfma_f32_16x16x32_bf16 v[160:163], a[184:187], a[24:27], v[160:163]
    v_mfma_f32_16x16x32_bf16 v[160:163], a[188:191], a[28:31], v[160:163]
    s_nop 7
    v_max3_f32 v209, v160, v161, v162
    v_max_f32 v209, v209, v163
    v_mov_b32 v251, v209
    s_nop 1
    v_permlane32_swap_b32 v251, v209
    v_max_f32 v209, v209, v251
    v_mov_b32 v251, v209
    s_nop 1
    v_permlane16_swap_b32 v251, v209
    v_max_f32 v209, v209, v251
    s_waitcnt vmcnt(16) lgkmcnt(0)
    s_barrier
    ds_write_b32 v246, v209 offset:0
    v_add_u32 v242, 147456, v238
    v_add_u32 v243, 147456, v239
    v_add_u32 v244, 147456, v240
    v_add_u32 v245, 147456, v241
    ds_read_b128 a[32:35], v242 offset:0
    ds_read_b128 a[36:39], v243 offset:0
    ds_read_b128 a[40:43], v244 offset:0
    ds_read_b128 a[44:47], v245 offset:0
    ds_read_b128 a[48:51], v242 offset:256
    ds_read_b128 a[52:55], v243 offset:256
    ds_read_b128 a[56:59], v244 offset:256
    ds_read_b128 a[60:63], v245 offset:256
    s_add_u32 m0, s25, 65536
    s_nop 0
    buffer_load_dwordx4 v232, s[16:19], s27 offen offset:0 nt lds
    buffer_load_dwordx4 v233, s[16:19], s27 offen offset:1024 nt lds
    buffer_load_dwordx4 v234, s[16:19], s27 offen offset:2048 nt lds
    buffer_load_dwordx4 v235, s[16:19], s27 offen offset:3072 nt lds
    s_add_u32 s27, s27, 16384
    s_and_b32 s27, s27, 0x7ffff
    s_waitcnt lgkmcnt(0)
    v_mfma_f32_16x16x32_bf16 v[164:167], a[160:163], a[32:35], 0
    v_mfma_f32_16x16x32_bf16 v[164:167], a[164:167], a[36:39], v[164:167]
    v_mfma_f32_16x16x32_bf16 v[164:167], a[168:171], a[40:43], v[164:167]
    v_mfma_f32_16x16x32_bf16 v[164:167], a[172:175], a[44:47], v[164:167]
    v_mfma_f32_16x16x32_bf16 v[164:167], a[176:179], a[48:51], v[164:167]
    v_mfma_f32_16x16x32_bf16 v[164:167], a[180:183], a[52:55], v[164:167]
    v_mfma_f32_16x16x32_bf16 v[164:167], a[184:187], a[56:59], v[164:167]
    v_mfma_f32_16x16x32_bf16 v[164:167], a[188:191], a[60:63], v[164:167]
    s_nop 7
    v_max3_f32 v210, v164, v165, v166
    v_max_f32 v210, v210, v167
    v_mov_b32 v251, v210
    s_nop 1
    v_permlane32_swap_b32 v251, v210
    v_max_f32 v210, v210, v251
    v_mov_b32 v251, v210
    s_nop 1
    v_permlane16_swap_b32 v251, v210
    v_max_f32 v210, v210, v251
    s_waitcnt vmcnt(16) lgkmcnt(0)
    s_barrier
    ds_read_b32 v252, v247 offset:0
    ds_write_b32 v246, v210 offset:256
    v_add_u32 v242, 49152, v238
    v_add_u32 v243, 49152, v239
    v_add_u32 v244, 49152, v240
    v_add_u32 v245, 49152, v241
    ds_read_b128 a[64:67], v242 offset:0
    ds_read_b128 a[68:71], v243 offset:0
    ds_read_b128 a[72:75], v244 offset:0
    ds_read_b128 a[76:79], v245 offset:0
    ds_read_b128 a[80:83], v242 offset:256
    ds_read_b128 a[84:87], v243 offset:256
    ds_read_b128 a[88:91], v244 offset:256
    ds_read_b128 a[92:95], v245 offset:256
    s_add_u32 m0, s25, 32768
    s_nop 0
    buffer_load_dwordx4 v228, s[12:15], s26 offen offset:0 nt lds
    buffer_load_dwordx4 v229, s[12:15], s26 offen offset:1024 nt lds
    buffer_load_dwordx4 v230, s[12:15], s26 offen offset:2048 nt lds
    buffer_load_dwordx4 v231, s[12:15], s26 offen offset:3072 nt lds
    s_add_u32 s26, s26, 16384
    s_and_b32 s26, s26, 0x7ffff
    s_waitcnt lgkmcnt(9)
    v_max_f32 v209, v209, v252
    v_mul_f32 v209, s24, v209
    v_fma_f32 v160, v160, s24, -v209
    v_fma_f32 v161, v161, s24, -v209
    v_fma_f32 v162, v162, s24, -v209
    v_fma_f32 v163, v163, s24, -v209
    v_exp_f32 v160, v160
    v_exp_f32 v161, v161
    v_exp_f32 v162, v162
    v_exp_f32 v163, v163
    s_nop 0
    v_cvt_pk_bf16_f32 v200, v160, v161
    v_cvt_pk_bf16_f32 v201, v162, v163
    v_add_f32 v204, v204, v160
    v_add_f32 v204, v204, v161
    v_add_f32 v204, v204, v162
    v_add_f32 v204, v204, v163
    ds_write_b64 v226, v[200:201] offset:0
    s_waitcnt lgkmcnt(1)
    v_mfma_f32_16x16x32_bf16 v[168:171], a[160:163], a[64:67], 0
    v_mfma_f32_16x16x32_bf16 v[168:171], a[164:167], a[68:71], v[168:171]
    v_mfma_f32_16x16x32_bf16 v[168:171], a[168:171], a[72:75], v[168:171]
    v_mfma_f32_16x16x32_bf16 v[168:171], a[172:175], a[76:79], v[168:171]
    v_mfma_f32_16x16x32_bf16 v[168:171], a[176:179], a[80:83], v[168:171]
    v_mfma_f32_16x16x32_bf16 v[168:171], a[180:183], a[84:87], v[168:171]
    v_mfma_f32_16x16x32_bf16 v[168:171], a[184:187], a[88:91], v[168:171]
    v_mfma_f32_16x16x32_bf16 v[168:171], a[188:191], a[92:95], v[168:171]
    s_nop 7
    v_max3_f32 v211, v168, v169, v170
    v_max_f32 v211, v211, v171
    v_mov_b32 v251, v211
    s_nop 1
    v_permlane32_swap_b32 v251, v211
    v_max_f32 v211, v211, v251
    v_mov_b32 v251, v211
    s_nop 1
    v_permlane16_swap_b32 v251, v211
    v_max_f32 v211, v211, v251
    s_waitcnt vmcnt(16) lgkmcnt(0)
    s_barrier
    ds_read_b32 v252, v247 offset:256
    ds_write_b32 v246, v211 offset:512
    v_add_u32 v242, 98304, v238
    v_add_u32 v243, 98304, v239
    v_add_u32 v244, 98304, v240
    v_add_u32 v245, 98304, v241
    ds_read_b128 a[96:99], v242 offset:0
    ds_read_b128 a[100:103], v243 offset:0
    ds_read_b128 a[104:107], v244 offset:0
    ds_read_b128 a[108:111], v245 offset:0
    ds_read_b128 a[112:115], v242 offset:256
    ds_read_b128 a[116:119], v243 offset:256
    ds_read_b128 a[120:123], v244 offset:256
    ds_read_b128 a[124:127], v245 offset:256
    s_add_u32 m0, s25, 81920
    s_nop 0
    buffer_load_dwordx4 v232, s[16:19], s27 offen offset:0 nt lds
    buffer_load_dwordx4 v233, s[16:19], s27 offen offset:1024 nt lds
    buffer_load_dwordx4 v234, s[16:19], s27 offen offset:2048 nt lds
    buffer_load_dwordx4 v235, s[16:19], s27 offen offset:3072 nt lds
    s_add_u32 s27, s27, 16384
    s_and_b32 s27, s27, 0x7ffff
    s_waitcnt lgkmcnt(9)
    v_max_f32 v210, v210, v252
    v_mul_f32 v210, s24, v210
    v_fma_f32 v164, v164, s24, -v210
    v_fma_f32 v165, v165, s24, -v210
    v_fma_f32 v166, v166, s24, -v210
    v_fma_f32 v167, v167, s24, -v210
    v_exp_f32 v164, v164
    v_exp_f32 v165, v165
    v_exp_f32 v166, v166
    v_exp_f32 v167, v167
    s_nop 0
    v_cvt_pk_bf16_f32 v202, v164, v165
    v_cvt_pk_bf16_f32 v203, v166, v167
    v_add_f32 v205, v205, v164
    v_add_f32 v205, v205, v165
    v_add_f32 v205, v205, v166
    v_add_f32 v205, v205, v167
    ds_write_b64 v226, v[202:203] offset:1024
    s_waitcnt lgkmcnt(1)
    v_mfma_f32_16x16x32_bf16 v[172:175], a[160:163], a[96:99], 0
    v_mfma_f32_16x16x32_bf16 v[172:175], a[164:167], a[100:103], v[172:175]
    v_mfma_f32_16x16x32_bf16 v[172:175], a[168:171], a[104:107], v[172:175]
    v_mfma_f32_16x16x32_bf16 v[172:175], a[172:175], a[108:111], v[172:175]
    v_mfma_f32_16x16x32_bf16 v[172:175], a[176:179], a[112:115], v[172:175]
    v_mfma_f32_16x16x32_bf16 v[172:175], a[180:183], a[116:119], v[172:175]
    v_mfma_f32_16x16x32_bf16 v[172:175], a[184:187], a[120:123], v[172:175]
    v_mfma_f32_16x16x32_bf16 v[172:175], a[188:191], a[124:127], v[172:175]
    s_nop 7
    v_max3_f32 v212, v172, v173, v174
    v_max_f32 v212, v212, v175
    v_mov_b32 v251, v212
    s_nop 1
    v_permlane32_swap_b32 v251, v212
    v_max_f32 v212, v212, v251
    v_mov_b32 v251, v212
    s_nop 1
    v_permlane16_swap_b32 v251, v212
    v_max_f32 v212, v212, v251
    s_waitcnt vmcnt(16) lgkmcnt(0)
    s_barrier
    ds_read_b32 v252, v247 offset:512
    ds_write_b32 v246, v212 offset:768
    v_add_u32 v242, 114688, v238
    v_add_u32 v243, 114688, v239
    v_add_u32 v244, 114688, v240
    v_add_u32 v245, 114688, v241
    ds_read_b128 a[128:131], v242 offset:0
    ds_read_b128 a[132:135], v243 offset:0
    ds_read_b128 a[136:139], v244 offset:0
    ds_read_b128 a[140:143], v245 offset:0
    ds_read_b128 a[144:147], v242 offset:256
    ds_read_b128 a[148:151], v243 offset:256
    ds_read_b128 a[152:155], v244 offset:256
    ds_read_b128 a[156:159], v245 offset:256
    s_waitcnt lgkmcnt(9)
    v_max_f32 v211, v211, v252
    v_mul_f32 v211, s24, v211
    v_fma_f32 v168, v168, s24, -v211
    v_fma_f32 v169, v169, s24, -v211
    v_fma_f32 v170, v170, s24, -v211
    v_fma_f32 v171, v171, s24, -v211
    v_exp_f32 v168, v168
    v_exp_f32 v169, v169
    v_exp_f32 v170, v170
    v_exp_f32 v171, v171
    s_nop 0
    v_cvt_pk_bf16_f32 v200, v168, v169
    v_cvt_pk_bf16_f32 v201, v170, v171
    v_add_f32 v206, v206, v168
    v_add_f32 v206, v206, v169
    v_add_f32 v206, v206, v170
    v_add_f32 v206, v206, v171
    ds_write_b64 v226, v[200:201] offset:2048
    s_waitcnt lgkmcnt(1)
    v_mfma_f32_16x16x32_bf16 v[176:179], a[160:163], a[128:131], 0
    v_mfma_f32_16x16x32_bf16 v[176:179], a[164:167], a[132:135], v[176:179]
    v_mfma_f32_16x16x32_bf16 v[176:179], a[168:171], a[136:139], v[176:179]
    v_mfma_f32_16x16x32_bf16 v[176:179], a[172:175], a[140:143], v[176:179]
    v_mfma_f32_16x16x32_bf16 v[176:179], a[176:179], a[144:147], v[176:179]
    v_mfma_f32_16x16x32_bf16 v[176:179], a[180:183], a[148:151], v[176:179]
    v_mfma_f32_16x16x32_bf16 v[176:179], a[184:187], a[152:155], v[176:179]
    v_mfma_f32_16x16x32_bf16 v[176:179], a[188:191], a[156:159], v[176:179]
    s_nop 7
    v_max3_f32 v213, v176, v177, v178
    v_max_f32 v213, v213, v179
    v_mov_b32 v251, v213
    s_nop 1
    v_permlane32_swap_b32 v251, v213
    v_max_f32 v213, v213, v251
    v_mov_b32 v251, v213
    s_nop 1
    v_permlane16_swap_b32 v251, v213
    v_max_f32 v213, v213, v251
    ds_write_b32 v237, v213 offset:1024
    s_waitcnt vmcnt(12) lgkmcnt(0)
    s_barrier
    ds_read_b32 v252, v247 offset:768
    ds_read_b32 v253, v248 offset:1024
    ds_read_b128 a[160:163], v214 offset:16384
    ds_read_b128 a[164:167], v215 offset:16384
    ds_read_b128 a[168:171], v216 offset:16384
    ds_read_b128 a[172:175], v217 offset:16384
    ds_read_b128 a[176:179], v214 offset:16640
    ds_read_b128 a[180:183], v215 offset:16640
    ds_read_b128 a[184:187], v216 offset:16640
    ds_read_b128 a[188:191], v217 offset:16640
    s_waitcnt lgkmcnt(8)
    v_max_f32 v212, v212, v252
    v_mul_f32 v212, s24, v212
    v_fma_f32 v172, v172, s24, -v212
    v_fma_f32 v173, v173, s24, -v212
    v_fma_f32 v174, v174, s24, -v212
    v_fma_f32 v175, v175, s24, -v212
    v_exp_f32 v172, v172
    v_exp_f32 v173, v173
    v_exp_f32 v174, v174
    v_exp_f32 v175, v175
    s_nop 0
    v_cvt_pk_bf16_f32 v202, v172, v173
    v_cvt_pk_bf16_f32 v203, v174, v175
    v_add_f32 v207, v207, v172
    v_add_f32 v207, v207, v173
    v_add_f32 v207, v207, v174
    v_add_f32 v207, v207, v175
    ds_write_b64 v226, v[202:203] offset:3072
    v_max_f32 v213, v213, v253
    v_mul_f32 v213, s24, v213
    v_fma_f32 v176, v176, s24, -v213
    v_fma_f32 v177, v177, s24, -v213
    v_fma_f32 v178, v178, s24, -v213
    v_fma_f32 v179, v179, s24, -v213
    v_exp_f32 v176, v176
    v_exp_f32 v177, v177
    s_waitcnt lgkmcnt(0)
L_main_n5:
    v_mfma_f32_16x16x32_bf16 v[160:163], a[160:163], a[0:3], 0
    v_exp_f32 v178, v178
    v_mfma_f32_16x16x32_bf16 v[160:163], a[164:167], a[4:7], v[160:163]
    v_cvt_pk_bf16_f32 v200, v176, v177
    v_mfma_f32_16x16x32_bf16 v[160:163], a[168:171], a[8:11], v[160:163]
    v_exp_f32 v179, v179
    v_mfma_f32_16x16x32_bf16 v[160:163], a[172:175], a[12:15], v[160:163]
    v_mfma_f32_16x16x32_bf16 v[160:163], a[176:179], a[16:19], v[160:163]
    v_cvt_pk_bf16_f32 v201, v178, v179
    v_mfma_f32_16x16x32_bf16 v[160:163], a[180:183], a[20:23], v[160:163]
    ds_write_b64 v226, v[200:201] offset:4096
    v_add_f32 v208, v208, v176
    v_mfma_f32_16x16x32_bf16 v[160:163], a[184:187], a[24:27], v[160:163]
    v_add_f32 v208, v208, v177
    v_mfma_f32_16x16x32_bf16 v[160:163], a[188:191], a[28:31], v[160:163]
    v_add_f32 v208, v208, v178
    v_mfma_f32_16x16x32_bf16 v[164:167], a[160:163], a[32:35], 0
    s_waitcnt vmcnt(8)
    v_add_f32 v208, v208, v179
    v_mfma_f32_16x16x32_bf16 v[164:167], a[164:167], a[36:39], v[164:167]
    s_barrier
    v_mfma_f32_16x16x32_bf16 v[164:167], a[168:171], a[40:43], v[164:167]
    ds_read_b64_tr_b16 a[192:193], v218 offset:0
    v_fma_f32 v160, v160, s24, -v209
    v_mfma_f32_16x16x32_bf16 v[164:167], a[172:175], a[44:47], v[164:167]
    ds_read_b64_tr_b16 a[194:195], v218 offset:8192
    v_fma_f32 v161, v161, s24, -v209
    v_mfma_f32_16x16x32_bf16 v[164:167], a[176:179], a[48:51], v[164:167]
    v_exp_f32 v160, v160
    v_mfma_f32_16x16x32_bf16 v[164:167], a[180:183], a[52:55], v[164:167]
    ds_read_b64_tr_b16 a[196:197], v219 offset:0
    v_fma_f32 v162, v162, s24, -v209
    v_mfma_f32_16x16x32_bf16 v[164:167], a[184:187], a[56:59], v[164:167]
    v_exp_f32 v161, v161
    v_mfma_f32_16x16x32_bf16 v[164:167], a[188:191], a[60:63], v[164:167]
    ds_read_b64_tr_b16 a[198:199], v219 offset:8192
    v_fma_f32 v163, v163, s24, -v209
    v_mfma_f32_16x16x32_bf16 v[168:171], a[160:163], a[64:67], 0
    v_exp_f32 v162, v162
    v_mfma_f32_16x16x32_bf16 v[168:171], a[164:167], a[68:71], v[168:171]
    ds_read_b128 v[180:183], v227 offset:0
    v_cvt_pk_bf16_f32 v200, v160, v161
    v_mfma_f32_16x16x32_bf16 v[168:171], a[168:171], a[72:75], v[168:171]
    s_add_u32 m0, s25, 49152
    v_exp_f32 v163, v163
    v_mfma_f32_16x16x32_bf16 v[168:171], a[172:175], a[76:79], v[168:171]
    buffer_load_dwordx4 v228, s[12:15], s26 offen offset:0 nt lds
    v_mfma_f32_16x16x32_bf16 v[168:171], a[176:179], a[80:83], v[168:171]
    ds_read_b64_tr_b16 a[200:201], v220 offset:0
    v_cvt_pk_bf16_f32 v201, v162, v163
    v_mfma_f32_16x16x32_bf16 v[168:171], a[180:183], a[84:87], v[168:171]
    ds_write_b64 v226, v[200:201] offset:10240
    v_add_f32 v204, v204, v160
    v_mfma_f32_16x16x32_bf16 v[168:171], a[184:187], a[88:91], v[168:171]
    ds_read_b64_tr_b16 a[202:203], v220 offset:8192
    v_add_f32 v204, v204, v161
    v_mfma_f32_16x16x32_bf16 v[168:171], a[188:191], a[92:95], v[168:171]
    ds_read_b64_tr_b16 a[204:205], v221 offset:0
    v_add_f32 v204, v204, v162
    v_mfma_f32_16x16x32_bf16 v[172:175], a[160:163], a[96:99], 0
    ds_read_b64_tr_b16 a[206:207], v221 offset:8192
    v_add_f32 v204, v204, v163
    v_mfma_f32_16x16x32_bf16 v[172:175], a[164:167], a[100:103], v[172:175]
    buffer_load_dwordx4 v229, s[12:15], s26 offen offset:1024 nt lds
    v_mfma_f32_16x16x32_bf16 v[172:175], a[168:171], a[104:107], v[172:175]
    ds_read_b64_tr_b16 a[208:209], v222 offset:0
    v_fma_f32 v164, v164, s24, -v210
    v_mfma_f32_16x16x32_bf16 v[172:175], a[172:175], a[108:111], v[172:175]
    ds_read_b64_tr_b16 a[210:211], v222 offset:8192
    v_fma_f32 v165, v165, s24, -v210
    v_mfma_f32_16x16x32_bf16 v[172:175], a[176:179], a[112:115], v[172:175]
    v_exp_f32 v164, v164
    v_mfma_f32_16x16x32_bf16 v[172:175], a[180:183], a[116:119], v[172:175]
    ds_read_b64_tr_b16 a[212:213], v223 offset:0
    v_fma_f32 v166, v166, s24, -v210
    v_mfma_f32_16x16x32_bf16 v[172:175], a[184:187], a[120:123], v[172:175]
    v_exp_f32 v165, v165
    v_mfma_f32_16x16x32_bf16 v[172:175], a[188:191], a[124:127], v[172:175]
    ds_read_b64_tr_b16 a[214:215], v223 offset:8192
    v_fma_f32 v167, v167, s24, -v210
    v_mfma_f32_16x16x32_bf16 v[176:179], a[160:163], a[128:131], 0
    v_exp_f32 v166, v166
    v_mfma_f32_16x16x32_bf16 v[176:179], a[164:167], a[132:135], v[176:179]
    ds_read_b64_tr_b16 a[216:217], v224 offset:0
    v_cvt_pk_bf16_f32 v202, v164, v165
    v_mfma_f32_16x16x32_bf16 v[176:179], a[168:171], a[136:139], v[176:179]
    v_exp_f32 v167, v167
    v_mfma_f32_16x16x32_bf16 v[176:179], a[172:175], a[140:143], v[176:179]
    buffer_load_dwordx4 v230, s[12:15], s26 offen offset:2048 nt lds
    v_mfma_f32_16x16x32_bf16 v[176:179], a[176:179], a[144:147], v[176:179]
    ds_read_b64_tr_b16 a[218:219], v224 offset:8192
    v_cvt_pk_bf16_f32 v203, v166, v167
    v_mfma_f32_16x16x32_bf16 v[176:179], a[180:183], a[148:151], v[176:179]
    ds_write_b64 v226, v[202:203] offset:11264
    v_add_f32 v205, v205, v164
    v_mfma_f32_16x16x32_bf16 v[176:179], a[184:187], a[152:155], v[176:179]
    ds_read_b64_tr_b16 a[220:221], v225 offset:0
    v_add_f32 v205, v205, v165
    v_mfma_f32_16x16x32_bf16 v[176:179], a[188:191], a[156:159], v[176:179]
    s_waitcnt lgkmcnt(4)
    ds_read_b64_tr_b16 a[222:223], v225 offset:8192
    v_add_f32 v205, v205, v166
    v_mfma_f32_16x16x32_bf16 v[0:3], a[192:195], v[180:183], v[0:3]
    ds_read_b128 v[184:187], v227 offset:1024
    v_add_f32 v205, v205, v167
    v_mfma_f32_16x16x32_bf16 v[4:7], a[196:199], v[180:183], v[4:7]
    buffer_load_dwordx4 v231, s[12:15], s26 offen offset:3072 nt lds
    v_mfma_f32_16x16x32_bf16 v[8:11], a[200:203], v[180:183], v[8:11]
    s_add_u32 s26, s26, 16384
    s_and_b32 s26, s26, 0x7ffff
    s_add_u32 m0, s25, 98304
    ds_read_b128 v[188:191], v227 offset:2048
    v_fma_f32 v168, v168, s24, -v211
    v_mfma_f32_16x16x32_bf16 v[12:15], a[204:207], v[180:183], v[12:15]
    buffer_load_dwordx4 v232, s[16:19], s27 offen offset:0 nt lds
    v_fma_f32 v169, v169, s24, -v211
    v_mfma_f32_16x16x32_bf16 v[16:19], a[208:211], v[180:183], v[16:19]
    s_waitcnt vmcnt(9) lgkmcnt(2)
    v_exp_f32 v168, v168
    v_mfma_f32_16x16x32_bf16 v[20:23], a[212:215], v[180:183], v[20:23]
    s_barrier
    v_fma_f32 v170, v170, s24, -v211
    v_mfma_f32_16x16x32_bf16 v[24:27], a[216:219], v[180:183], v[24:27]
    v_exp_f32 v169, v169
    v_mfma_f32_16x16x32_bf16 v[28:31], a[220:223], v[180:183], v[28:31]
    s_waitcnt lgkmcnt(1)
    buffer_load_dwordx4 v233, s[16:19], s27 offen offset:1024 nt lds
    v_fma_f32 v171, v171, s24, -v211
    v_mfma_f32_16x16x32_bf16 v[32:35], a[192:195], v[184:187], v[32:35]
    v_exp_f32 v170, v170
    v_mfma_f32_16x16x32_bf16 v[36:39], a[196:199], v[184:187], v[36:39]
    ds_read_b128 a[160:163], v214 offset:32768
    v_cvt_pk_bf16_f32 v200, v168, v169
    v_mfma_f32_16x16x32_bf16 v[40:43], a[200:203], v[184:187], v[40:43]
    v_exp_f32 v171, v171
    v_mfma_f32_16x16x32_bf16 v[44:47], a[204:207], v[184:187], v[44:47]
    buffer_load_dwordx4 v234, s[16:19], s27 offen offset:2048 nt lds
    v_mfma_f32_16x16x32_bf16 v[48:51], a[208:211], v[184:187], v[48:51]
    ds_read_b128 v[192:195], v227 offset:3072
    v_cvt_pk_bf16_f32 v201, v170, v171
    v_mfma_f32_16x16x32_bf16 v[52:55], a[212:215], v[184:187], v[52:55]
    ds_write_b64 v226, v[200:201] offset:12288
    v_add_f32 v206, v206, v168
    v_mfma_f32_16x16x32_bf16 v[56:59], a[216:219], v[184:187], v[56:59]
    ds_read_b128 a[164:167], v215 offset:32768
    v_add_f32 v206, v206, v169
    v_mfma_f32_16x16x32_bf16 v[60:63], a[220:223], v[184:187], v[60:63]
    s_waitcnt lgkmcnt(4)
    buffer_load_dwordx4 v235, s[16:19], s27 offen offset:3072 nt lds
    v_add_f32 v206, v206, v170
    v_mfma_f32_16x16x32_bf16 v[64:67], a[192:195], v[188:191], v[64:67]
    s_add_u32 s27, s27, 16384
    s_and_b32 s27, s27, 0x7ffff
    ds_read_b128 a[168:171], v216 offset:32768
    v_add_f32 v206, v206, v171
    v_mfma_f32_16x16x32_bf16 v[68:71], a[196:199], v[188:191], v[68:71]
    s_add_u32 m0, s25, 0
    ds_read_b128 a[172:175], v217 offset:32768
    v_mfma_f32_16x16x32_bf16 v[72:75], a[200:203], v[188:191], v[72:75]
    buffer_load_dwordx4 v228, s[12:15], s26 offen offset:0 nt lds
    v_fma_f32 v172, v172, s24, -v212
    v_mfma_f32_16x16x32_bf16 v[76:79], a[204:207], v[188:191], v[76:79]
    ds_read_b128 v[196:199], v227 offset:4096
    v_fma_f32 v173, v173, s24, -v212
    v_mfma_f32_16x16x32_bf16 v[80:83], a[208:211], v[188:191], v[80:83]
    v_exp_f32 v172, v172
    v_mfma_f32_16x16x32_bf16 v[84:87], a[212:215], v[188:191], v[84:87]
    ds_read_b128 a[176:179], v214 offset:33024
    v_fma_f32 v174, v174, s24, -v212
    v_mfma_f32_16x16x32_bf16 v[88:91], a[216:219], v[188:191], v[88:91]
    v_exp_f32 v173, v173
    v_mfma_f32_16x16x32_bf16 v[92:95], a[220:223], v[188:191], v[92:95]
    s_waitcnt lgkmcnt(3)
    buffer_load_dwordx4 v229, s[12:15], s26 offen offset:1024 nt lds
    v_fma_f32 v175, v175, s24, -v212
    v_mfma_f32_16x16x32_bf16 v[96:99], a[192:195], v[192:195], v[96:99]
    v_exp_f32 v174, v174
    v_mfma_f32_16x16x32_bf16 v[100:103], a[196:199], v[192:195], v[100:103]
    ds_read_b128 a[180:183], v215 offset:33024
    v_cvt_pk_bf16_f32 v202, v172, v173
    v_mfma_f32_16x16x32_bf16 v[104:107], a[200:203], v[192:195], v[104:107]
    v_exp_f32 v175, v175
    v_mfma_f32_16x16x32_bf16 v[108:111], a[204:207], v[192:195], v[108:111]
    buffer_load_dwordx4 v230, s[12:15], s26 offen offset:2048 nt lds
    v_mfma_f32_16x16x32_bf16 v[112:115], a[208:211], v[192:195], v[112:115]
    ds_read_b128 a[184:187], v216 offset:33024
    v_cvt_pk_bf16_f32 v203, v174, v175
    v_mfma_f32_16x16x32_bf16 v[116:119], a[212:215], v[192:195], v[116:119]
    ds_write_b64 v226, v[202:203] offset:13312
    v_add_f32 v207, v207, v172
    v_mfma_f32_16x16x32_bf16 v[120:123], a[216:219], v[192:195], v[120:123]
    buffer_load_dwordx4 v231, s[12:15], s26 offen offset:3072 nt lds
    v_add_f32 v207, v207, v173
    v_mfma_f32_16x16x32_bf16 v[124:127], a[220:223], v[192:195], v[124:127]
    s_waitcnt lgkmcnt(3)
    s_add_u32 s26, s26, 16384
    s_and_b32 s26, s26, 0x7ffff
    ds_read_b128 a[188:191], v217 offset:33024
    v_add_f32 v207, v207, v174
    v_mfma_f32_16x16x32_bf16 v[128:131], a[192:195], v[196:199], v[128:131]
    v_add_f32 v207, v207, v175
    v_mfma_f32_16x16x32_bf16 v[132:135], a[196:199], v[196:199], v[132:135]
    v_mfma_f32_16x16x32_bf16 v[136:139], a[200:203], v[196:199], v[136:139]
    v_fma_f32 v176, v176, s24, -v213
    v_mfma_f32_16x16x32_bf16 v[140:143], a[204:207], v[196:199], v[140:143]
    v_fma_f32 v177, v177, s24, -v213
    v_mfma_f32_16x16x32_bf16 v[144:147], a[208:211], v[196:199], v[144:147]
    v_exp_f32 v176, v176
    v_mfma_f32_16x16x32_bf16 v[148:151], a[212:215], v[196:199], v[148:151]
    v_fma_f32 v178, v178, s24, -v213
    v_mfma_f32_16x16x32_bf16 v[152:155], a[216:219], v[196:199], v[152:155]
    v_exp_f32 v177, v177
    v_mfma_f32_16x16x32_bf16 v[156:159], a[220:223], v[196:199], v[156:159]
    v_fma_f32 v179, v179, s24, -v213
    v_mfma_f32_16x16x32_bf16 v[160:163], a[160:163], a[0:3], 0
    v_exp_f32 v178, v178
    v_mfma_f32_16x16x32_bf16 v[160:163], a[164:167], a[4:7], v[160:163]
    v_cvt_pk_bf16_f32 v200, v176, v177
    v_mfma_f32_16x16x32_bf16 v[160:163], a[168:171], a[8:11], v[160:163]
    v_exp_f32 v179, v179
    v_mfma_f32_16x16x32_bf16 v[160:163], a[172:175], a[12:15], v[160:163]
    v_mfma_f32_16x16x32_bf16 v[160:163], a[176:179], a[16:19], v[160:163]
    s_waitcnt lgkmcnt(0)
    v_cvt_pk_bf16_f32 v201, v178, v179
    v_mfma_f32_16x16x32_bf16 v[160:163], a[180:183], a[20:23], v[160:163]
    ds_write_b64 v226, v[200:201] offset:14336
    v_add_f32 v208, v208, v176
    v_mfma_f32_16x16x32_bf16 v[160:163], a[184:187], a[24:27], v[160:163]
    v_add_f32 v208, v208, v177
    v_mfma_f32_16x16x32_bf16 v[160:163], a[188:191], a[28:31], v[160:163]
    v_add_f32 v208, v208, v178
    v_mfma_f32_16x16x32_bf16 v[164:167], a[160:163], a[32:35], 0
    s_waitcnt vmcnt(12)
    v_add_f32 v208, v208, v179
    v_mfma_f32_16x16x32_bf16 v[164:167], a[164:167], a[36:39], v[164:167]
    s_barrier
    v_mfma_f32_16x16x32_bf16 v[164:167], a[168:171], a[40:43], v[164:167]
    ds_read_b64_tr_b16 a[192:193], v218 offset:16384
    v_fma_f32 v160, v160, s24, -v209
    v_mfma_f32_16x16x32_bf16 v[164:167], a[172:175], a[44:47], v[164:167]
    ds_read_b64_tr_b16 a[194:195], v218 offset:24576
    v_fma_f32 v161, v161, s24, -v209
    v_mfma_f32_16x16x32_bf16 v[164:167], a[176:179], a[48:51], v[164:167]
    v_exp_f32 v160, v160
    v_mfma_f32_16x16x32_bf16 v[164:167], a[180:183], a[52:55], v[164:167]
    ds_read_b64_tr_b16 a[196:197], v219 offset:16384
    v_fma_f32 v162, v162, s24, -v209
    v_mfma_f32_16x16x32_bf16 v[164:167], a[184:187], a[56:59], v[164:167]
    v_exp_f32 v161, v161
    v_mfma_f32_16x16x32_bf16 v[164:167], a[188:191], a[60:63], v[164:167]
    ds_read_b64_tr_b16 a[198:199], v219 offset:24576
    v_fma_f32 v163, v163, s24, -v209
    v_mfma_f32_16x16x32_bf16 v[168:171], a[160:163], a[64:67], 0
    v_exp_f32 v162, v162
    v_mfma_f32_16x16x32_bf16 v[168:171], a[164:167], a[68:71], v[168:171]
    ds_read_b128 v[180:183], v227 offset:10240
    v_cvt_pk_bf16_f32 v200, v160, v161
    v_mfma_f32_16x16x32_bf16 v[168:171], a[168:171], a[72:75], v[168:171]
    s_add_u32 m0, s25, 114688
    v_exp_f32 v163, v163
    v_mfma_f32_16x16x32_bf16 v[168:171], a[172:175], a[76:79], v[168:171]
    buffer_load_dwordx4 v232, s[16:19], s27 offen offset:0 nt lds
    v_mfma_f32_16x16x32_bf16 v[168:171], a[176:179], a[80:83], v[168:171]
    ds_read_b64_tr_b16 a[200:201], v220 offset:16384
    v_cvt_pk_bf16_f32 v201, v162, v163
    v_mfma_f32_16x16x32_bf16 v[168:171], a[180:183], a[84:87], v[168:171]
    ds_write_b64 v226, v[200:201] offset:0
    v_add_f32 v204, v204, v160
    v_mfma_f32_16x16x32_bf16 v[168:171], a[184:187], a[88:91], v[168:171]
    ds_read_b64_tr_b16 a[202:203], v220 offset:24576
    v_add_f32 v204, v204, v161
    v_mfma_f32_16x16x32_bf16 v[168:171], a[188:191], a[92:95], v[168:171]
    ds_read_b64_tr_b16 a[204:205], v221 offset:16384
    v_add_f32 v204, v204, v162
    v_mfma_f32_16x16x32_bf16 v[172:175], a[160:163], a[96:99], 0
    ds_read_b64_tr_b16 a[206:207], v221 offset:24576
    v_add_f32 v204, v204, v163
    v_mfma_f32_16x16x32_bf16 v[172:175], a[164:167], a[100:103], v[172:175]
    buffer_load_dwordx4 v233, s[16:19], s27 offen offset:1024 nt lds
    v_mfma_f32_16x16x32_bf16 v[172:175], a[168:171], a[104:107], v[172:175]
    ds_read_b64_tr_b16 a[208:209], v222 offset:16384
    v_fma_f32 v164, v164, s24, -v210
    v_mfma_f32_16x16x32_bf16 v[172:175], a[172:175], a[108:111], v[172:175]
    ds_read_b64_tr_b16 a[210:211], v222 offset:24576
    v_fma_f32 v165, v165, s24, -v210
    v_mfma_f32_16x16x32_bf16 v[172:175], a[176:179], a[112:115], v[172:175]
    v_exp_f32 v164, v164
    v_mfma_f32_16x16x32_bf16 v[172:175], a[180:183], a[116:119], v[172:175]
    ds_read_b64_tr_b16 a[212:213], v223 offset:16384
    v_fma_f32 v166, v166, s24, -v210
    v_mfma_f32_16x16x32_bf16 v[172:175], a[184:187], a[120:123], v[172:175]
    v_exp_f32 v165, v165
    v_mfma_f32_16x16x32_bf16 v[172:175], a[188:191], a[124:127], v[172:175]
    ds_read_b64_tr_b16 a[214:215], v223 offset:24576
    v_fma_f32 v167, v167, s24, -v210
    v_mfma_f32_16x16x32_bf16 v[176:179], a[160:163], a[128:131], 0
    v_exp_f32 v166, v166
    v_mfma_f32_16x16x32_bf16 v[176:179], a[164:167], a[132:135], v[176:179]
    ds_read_b64_tr_b16 a[216:217], v224 offset:16384
    v_cvt_pk_bf16_f32 v202, v164, v165
    v_mfma_f32_16x16x32_bf16 v[176:179], a[168:171], a[136:139], v[176:179]
    v_exp_f32 v167, v167
    v_mfma_f32_16x16x32_bf16 v[176:179], a[172:175], a[140:143], v[176:179]
    buffer_load_dwordx4 v234, s[16:19], s27 offen offset:2048 nt lds
    v_mfma_f32_16x16x32_bf16 v[176:179], a[176:179], a[144:147], v[176:179]
    ds_read_b64_tr_b16 a[218:219], v224 offset:24576
    v_cvt_pk_bf16_f32 v203, v166, v167
    v_mfma_f32_16x16x32_bf16 v[176:179], a[180:183], a[148:151], v[176:179]
    ds_write_b64 v226, v[202:203] offset:1024
    v_add_f32 v205, v205, v164
    v_mfma_f32_16x16x32_bf16 v[176:179], a[184:187], a[152:155], v[176:179]
    ds_read_b64_tr_b16 a[220:221], v225 offset:16384
    v_add_f32 v205, v205, v165
    v_mfma_f32_16x16x32_bf16 v[176:179], a[188:191], a[156:159], v[176:179]
    s_waitcnt lgkmcnt(4)
    ds_read_b64_tr_b16 a[222:223], v225 offset:24576
    v_add_f32 v205, v205, v166
    v_mfma_f32_16x16x32_bf16 v[0:3], a[192:195], v[180:183], v[0:3]
    ds_read_b128 v[184:187], v227 offset:11264
    v_add_f32 v205, v205, v167
    v_mfma_f32_16x16x32_bf16 v[4:7], a[196:199], v[180:183], v[4:7]
    buffer_load_dwordx4 v235, s[16:19], s27 offen offset:3072 nt lds
    v_mfma_f32_16x16x32_bf16 v[8:11], a[200:203], v[180:183], v[8:11]
    s_add_u32 s27, s27, 16384
    s_and_b32 s27, s27, 0x7ffff
    s_add_u32 m0, s25, 16384
    ds_read_b128 v[188:191], v227 offset:12288
    v_fma_f32 v168, v168, s24, -v211
    v_mfma_f32_16x16x32_bf16 v[12:15], a[204:207], v[180:183], v[12:15]
    buffer_load_dwordx4 v228, s[12:15], s26 offen offset:0 nt lds
    v_fma_f32 v169, v169, s24, -v211
    v_mfma_f32_16x16x32_bf16 v[16:19], a[208:211], v[180:183], v[16:19]
    s_waitcnt vmcnt(13) lgkmcnt(2)
    v_exp_f32 v168, v168
    v_mfma_f32_16x16x32_bf16 v[20:23], a[212:215], v[180:183], v[20:23]
    s_barrier
    v_fma_f32 v170, v170, s24, -v211
    v_mfma_f32_16x16x32_bf16 v[24:27], a[216:219], v[180:183], v[24:27]
    v_exp_f32 v169, v169
    v_mfma_f32_16x16x32_bf16 v[28:31], a[220:223], v[180:183], v[28:31]
    s_waitcnt lgkmcnt(1)
    buffer_load_dwordx4 v229, s[12:15], s26 offen offset:1024 nt lds
    v_fma_f32 v171, v171, s24, -v211
    v_mfma_f32_16x16x32_bf16 v[32:35], a[192:195], v[184:187], v[32:35]
    v_exp_f32 v170, v170
    v_mfma_f32_16x16x32_bf16 v[36:39], a[196:199], v[184:187], v[36:39]
    ds_read_b128 a[160:163], v214 offset:49152
    v_cvt_pk_bf16_f32 v200, v168, v169
    v_mfma_f32_16x16x32_bf16 v[40:43], a[200:203], v[184:187], v[40:43]
    v_exp_f32 v171, v171
    v_mfma_f32_16x16x32_bf16 v[44:47], a[204:207], v[184:187], v[44:47]
    buffer_load_dwordx4 v230, s[12:15], s26 offen offset:2048 nt lds
    v_mfma_f32_16x16x32_bf16 v[48:51], a[208:211], v[184:187], v[48:51]
    ds_read_b128 v[192:195], v227 offset:13312
    v_cvt_pk_bf16_f32 v201, v170, v171
    v_mfma_f32_16x16x32_bf16 v[52:55], a[212:215], v[184:187], v[52:55]
    ds_write_b64 v226, v[200:201] offset:2048
    v_add_f32 v206, v206, v168
    v_mfma_f32_16x16x32_bf16 v[56:59], a[216:219], v[184:187], v[56:59]
    ds_read_b128 a[164:167], v215 offset:49152
    v_add_f32 v206, v206, v169
    v_mfma_f32_16x16x32_bf16 v[60:63], a[220:223], v[184:187], v[60:63]
    s_waitcnt lgkmcnt(4)
    buffer_load_dwordx4 v231, s[12:15], s26 offen offset:3072 nt lds
    v_add_f32 v206, v206, v170
    v_mfma_f32_16x16x32_bf16 v[64:67], a[192:195], v[188:191], v[64:67]
    s_add_u32 s26, s26, 16384
    s_and_b32 s26, s26, 0x7ffff
    ds_read_b128 a[168:171], v216 offset:49152
    v_add_f32 v206, v206, v171
    v_mfma_f32_16x16x32_bf16 v[68:71], a[196:199], v[188:191], v[68:71]
    s_add_u32 m0, s25, 65536
    ds_read_b128 a[172:175], v217 offset:49152
    v_mfma_f32_16x16x32_bf16 v[72:75], a[200:203], v[188:191], v[72:75]
    buffer_load_dwordx4 v232, s[16:19], s27 offen offset:0 nt lds
    v_fma_f32 v172, v172, s24, -v212
    v_mfma_f32_16x16x32_bf16 v[76:79], a[204:207], v[188:191], v[76:79]
    ds_read_b128 v[196:199], v227 offset:14336
    v_fma_f32 v173, v173, s24, -v212
    v_mfma_f32_16x16x32_bf16 v[80:83], a[208:211], v[188:191], v[80:83]
    v_exp_f32 v172, v172
    v_mfma_f32_16x16x32_bf16 v[84:87], a[212:215], v[188:191], v[84:87]
    ds_read_b128 a[176:179], v214 offset:49408
    v_fma_f32 v174, v174, s24, -v212
    v_mfma_f32_16x16x32_bf16 v[88:91], a[216:219], v[188:191], v[88:91]
    v_exp_f32 v173, v173
    v_mfma_f32_16x16x32_bf16 v[92:95], a[220:223], v[188:191], v[92:95]
    s_waitcnt lgkmcnt(3)
    buffer_load_dwordx4 v233, s[16:19], s27 offen offset:1024 nt lds
    v_fma_f32 v175, v175, s24, -v212
    v_mfma_f32_16x16x32_bf16 v[96:99], a[192:195], v[192:195], v[96:99]
    v_exp_f32 v174, v174
    v_mfma_f32_16x16x32_bf16 v[100:103], a[196:199], v[192:195], v[100:103]
    ds_read_b128 a[180:183], v215 offset:49408
    v_cvt_pk_bf16_f32 v202, v172, v173
    v_mfma_f32_16x16x32_bf16 v[104:107], a[200:203], v[192:195], v[104:107]
    v_exp_f32 v175, v175
    v_mfma_f32_16x16x32_bf16 v[108:111], a[204:207], v[192:195], v[108:111]
    buffer_load_dwordx4 v234, s[16:19], s27 offen offset:2048 nt lds
    v_mfma_f32_16x16x32_bf16 v[112:115], a[208:211], v[192:195], v[112:115]
    ds_read_b128 a[184:187], v216 offset:49408
    v_cvt_pk_bf16_f32 v203, v174, v175
    v_mfma_f32_16x16x32_bf16 v[116:119], a[212:215], v[192:195], v[116:119]
    ds_write_b64 v226, v[202:203] offset:3072
    v_add_f32 v207, v207, v172
    v_mfma_f32_16x16x32_bf16 v[120:123], a[216:219], v[192:195], v[120:123]
    buffer_load_dwordx4 v235, s[16:19], s27 offen offset:3072 nt lds
    v_add_f32 v207, v207, v173
    v_mfma_f32_16x16x32_bf16 v[124:127], a[220:223], v[192:195], v[124:127]
    s_waitcnt lgkmcnt(3)
    s_add_u32 s27, s27, 16384
    s_and_b32 s27, s27, 0x7ffff
    ds_read_b128 a[188:191], v217 offset:49408
    v_add_f32 v207, v207, v174
    v_mfma_f32_16x16x32_bf16 v[128:131], a[192:195], v[196:199], v[128:131]
    v_add_f32 v207, v207, v175
    v_mfma_f32_16x16x32_bf16 v[132:135], a[196:199], v[196:199], v[132:135]
    v_mfma_f32_16x16x32_bf16 v[136:139], a[200:203], v[196:199], v[136:139]
    v_fma_f32 v176, v176, s24, -v213
    v_mfma_f32_16x16x32_bf16 v[140:143], a[204:207], v[196:199], v[140:143]
    v_fma_f32 v177, v177, s24, -v213
    v_mfma_f32_16x16x32_bf16 v[144:147], a[208:211], v[196:199], v[144:147]
    v_exp_f32 v176, v176
    v_mfma_f32_16x16x32_bf16 v[148:151], a[212:215], v[196:199], v[148:151]
    v_fma_f32 v178, v178, s24, -v213
    v_mfma_f32_16x16x32_bf16 v[152:155], a[216:219], v[196:199], v[152:155]
    v_exp_f32 v177, v177
    v_mfma_f32_16x16x32_bf16 v[156:159], a[220:223], v[196:199], v[156:159]
    v_fma_f32 v179, v179, s24, -v213
    s_waitcnt lgkmcnt(0)
    s_mov_b32 s28, 0
L_loop_n5:
    v_mfma_f32_16x16x32_bf16 v[160:163], a[160:163], a[0:3], 0
    v_exp_f32 v178, v178
    v_mfma_f32_16x16x32_bf16 v[160:163], a[164:167], a[4:7], v[160:163]
    v_cvt_pk_bf16_f32 v200, v176, v177
    v_mfma_f32_16x16x32_bf16 v[160:163], a[168:171], a[8:11], v[160:163]
    v_exp_f32 v179, v179
    v_mfma_f32_16x16x32_bf16 v[160:163], a[172:175], a[12:15], v[160:163]
    v_mfma_f32_16x16x32_bf16 v[160:163], a[176:179], a[16:19], v[160:163]
    v_cvt_pk_bf16_f32 v201, v178, v179
    v_mfma_f32_16x16x32_bf16 v[160:163], a[180:183], a[20:23], v[160:163]
    s_waitcnt lgkmcnt(0)
    ds_write_b64 v226, v[200:201] offset:4096
    v_add_f32 v208, v208, v176
    v_mfma_f32_16x16x32_bf16 v[160:163], a[184:187], a[24:27], v[160:163]
    v_add_f32 v208, v208, v177
    v_mfma_f32_16x16x32_bf16 v[160:163], a[188:191], a[28:31], v[160:163]
    v_add_f32 v208, v208, v178
    v_mfma_f32_16x16x32_bf16 v[164:167], a[160:163], a[32:35], 0
    s_waitcnt vmcnt(16)
    v_add_f32 v208, v208, v179
    v_mfma_f32_16x16x32_bf16 v[164:167], a[164:167], a[36:39], v[164:167]
    s_barrier
    v_mfma_f32_16x16x32_bf16 v[164:167], a[168:171], a[40:43], v[164:167]
    ds_read_b64_tr_b16 a[192:193], v218 offset:32768
    v_fma_f32 v160, v160, s24, -v209
    v_mfma_f32_16x16x32_bf16 v[164:167], a[172:175], a[44:47], v[164:167]
    ds_read_b64_tr_b16 a[194:195], v218 offset:40960
    v_fma_f32 v161, v161, s24, -v209
    v_mfma_f32_16x16x32_bf16 v[164:167], a[176:179], a[48:51], v[164:167]
    v_exp_f32 v160, v160
    v_mfma_f32_16x16x32_bf16 v[164:167], a[180:183], a[52:55], v[164:167]
    ds_read_b64_tr_b16 a[196:197], v219 offset:32768
    v_fma_f32 v162, v162, s24, -v209
    v_mfma_f32_16x16x32_bf16 v[164:167], a[184:187], a[56:59], v[164:167]
    v_exp_f32 v161, v161
    v_mfma_f32_16x16x32_bf16 v[164:167], a[188:191], a[60:63], v[164:167]
    ds_read_b64_tr_b16 a[198:199], v219 offset:40960
    v_fma_f32 v163, v163, s24, -v209
    v_mfma_f32_16x16x32_bf16 v[168:171], a[160:163], a[64:67], 0
    v_exp_f32 v162, v162
    v_mfma_f32_16x16x32_bf16 v[168:171], a[164:167], a[68:71], v[168:171]
    ds_read_b128 v[180:183], v227 offset:0
    v_cvt_pk_bf16_f32 v200, v160, v161
    v_mfma_f32_16x16x32_bf16 v[168:171], a[168:171], a[72:75], v[168:171]
    s_add_u32 m0, s25, 32768
    v_exp_f32 v163, v163
    v_mfma_f32_16x16x32_bf16 v[168:171], a[172:175], a[76:79], v[168:171]
    buffer_load_dwordx4 v228, s[12:15], s26 offen offset:0 nt lds
    v_mfma_f32_16x16x32_bf16 v[168:171], a[176:179], a[80:83], v[168:171]
    ds_read_b64_tr_b16 a[200:201], v220 offset:32768
    v_cvt_pk_bf16_f32 v201, v162, v163
    v_mfma_f32_16x16x32_bf16 v[168:171], a[180:183], a[84:87], v[168:171]
    ds_write_b64 v226, v[200:201] offset:10240
    v_add_f32 v204, v204, v160
    v_mfma_f32_16x16x32_bf16 v[168:171], a[184:187], a[88:91], v[168:171]
    ds_read_b64_tr_b16 a[202:203], v220 offset:40960
    v_add_f32 v204, v204, v161
    v_mfma_f32_16x16x32_bf16 v[168:171], a[188:191], a[92:95], v[168:171]
    ds_read_b64_tr_b16 a[204:205], v221 offset:32768
    v_add_f32 v204, v204, v162
    v_mfma_f32_16x16x32_bf16 v[172:175], a[160:163], a[96:99], 0
    ds_read_b64_tr_b16 a[206:207], v221 offset:40960
    v_add_f32 v204, v204, v163
    v_mfma_f32_16x16x32_bf16 v[172:175], a[164:167], a[100:103], v[172:175]
    buffer_load_dwordx4 v229, s[12:15], s26 offen offset:1024 nt lds
    v_mfma_f32_16x16x32_bf16 v[172:175], a[168:171], a[104:107], v[172:175]
    ds_read_b64_tr_b16 a[208:209], v222 offset:32768
    v_fma_f32 v164, v164, s24, -v210
    v_mfma_f32_16x16x32_bf16 v[172:175], a[172:175], a[108:111], v[172:175]
    ds_read_b64_tr_b16 a[210:211], v222 offset:40960
    v_fma_f32 v165, v165, s24, -v210
    v_mfma_f32_16x16x32_bf16 v[172:175], a[176:179], a[112:115], v[172:175]
    v_exp_f32 v164, v164
    v_mfma_f32_16x16x32_bf16 v[172:175], a[180:183], a[116:119], v[172:175]
    ds_read_b64_tr_b16 a[212:213], v223 offset:32768
    v_fma_f32 v166, v166, s24, -v210
    v_mfma_f32_16x16x32_bf16 v[172:175], a[184:187], a[120:123], v[172:175]
    v_exp_f32 v165, v165
    v_mfma_f32_16x16x32_bf16 v[172:175], a[188:191], a[124:127], v[172:175]
    ds_read_b64_tr_b16 a[214:215], v223 offset:40960
    v_fma_f32 v167, v167, s24, -v210
    v_mfma_f32_16x16x32_bf16 v[176:179], a[160:163], a[128:131], 0
    v_exp_f32 v166, v166
    v_mfma_f32_16x16x32_bf16 v[176:179], a[164:167], a[132:135], v[176:179]
    ds_read_b64_tr_b16 a[216:217], v224 offset:32768
    v_cvt_pk_bf16_f32 v202, v164, v165
    v_mfma_f32_16x16x32_bf16 v[176:179], a[168:171], a[136:139], v[176:179]
    v_exp_f32 v167, v167
    v_mfma_f32_16x16x32_bf16 v[176:179], a[172:175], a[140:143], v[176:179]
    buffer_load_dwordx4 v230, s[12:15], s26 offen offset:2048 nt lds
    v_mfma_f32_16x16x32_bf16 v[176:179], a[176:179], a[144:147], v[176:179]
    ds_read_b64_tr_b16 a[218:219], v224 offset:40960
    v_cvt_pk_bf16_f32 v203, v166, v167
    v_mfma_f32_16x16x32_bf16 v[176:179], a[180:183], a[148:151], v[176:179]
    ds_write_b64 v226, v[202:203] offset:11264
    v_add_f32 v205, v205, v164
    v_mfma_f32_16x16x32_bf16 v[176:179], a[184:187], a[152:155], v[176:179]
    ds_read_b64_tr_b16 a[220:221], v225 offset:32768
    v_add_f32 v205, v205, v165
    v_mfma_f32_16x16x32_bf16 v[176:179], a[188:191], a[156:159], v[176:179]
    s_waitcnt lgkmcnt(4)
    ds_read_b64_tr_b16 a[222:223], v225 offset:40960
    v_add_f32 v205, v205, v166
    v_mfma_f32_16x16x32_bf16 v[0:3], a[192:195], v[180:183], v[0:3]
    ds_read_b128 v[184:187], v227 offset:1024
    v_add_f32 v205, v205, v167
    v_mfma_f32_16x16x32_bf16 v[4:7], a[196:199], v[180:183], v[4:7]
    buffer_load_dwordx4 v231, s[12:15], s26 offen offset:3072 nt lds
    v_mfma_f32_16x16x32_bf16 v[8:11], a[200:203], v[180:183], v[8:11]
    s_add_u32 s26, s26, 16384
    ds_read_b128 v[188:191], v227 offset:2048
    v_fma_f32 v168, v168, s24, -v211
    v_mfma_f32_16x16x32_bf16 v[12:15], a[204:207], v[180:183], v[12:15]
    s_and_b32 s26, s26, 0x7ffff
    v_fma_f32 v169, v169, s24, -v211
    v_mfma_f32_16x16x32_bf16 v[16:19], a[208:211], v[180:183], v[16:19]
    s_waitcnt vmcnt(16) lgkmcnt(2)
    v_exp_f32 v168, v168
    v_mfma_f32_16x16x32_bf16 v[20:23], a[212:215], v[180:183], v[20:23]
    s_barrier
    v_fma_f32 v170, v170, s24, -v211
    v_mfma_f32_16x16x32_bf16 v[24:27], a[216:219], v[180:183], v[24:27]
    v_exp_f32 v169, v169
    v_mfma_f32_16x16x32_bf16 v[28:31], a[220:223], v[180:183], v[28:31]
    s_waitcnt lgkmcnt(1)
    ds_read_b128 a[160:163], v214 offset:0
    v_fma_f32 v171, v171, s24, -v211
    v_mfma_f32_16x16x32_bf16 v[32:35], a[192:195], v[184:187], v[32:35]
    v_exp_f32 v170, v170
    v_mfma_f32_16x16x32_bf16 v[36:39], a[196:199], v[184:187], v[36:39]
    ds_read_b128 a[164:167], v215 offset:0
    v_cvt_pk_bf16_f32 v200, v168, v169
    v_mfma_f32_16x16x32_bf16 v[40:43], a[200:203], v[184:187], v[40:43]
    s_add_u32 m0, s25, 81920
    v_exp_f32 v171, v171
    v_mfma_f32_16x16x32_bf16 v[44:47], a[204:207], v[184:187], v[44:47]
    buffer_load_dwordx4 v232, s[16:19], s27 offen offset:0 nt lds
    v_mfma_f32_16x16x32_bf16 v[48:51], a[208:211], v[184:187], v[48:51]
    ds_read_b128 v[192:195], v227 offset:3072
    v_cvt_pk_bf16_f32 v201, v170, v171
    v_mfma_f32_16x16x32_bf16 v[52:55], a[212:215], v[184:187], v[52:55]
    ds_write_b64 v226, v[200:201] offset:12288
    v_add_f32 v206, v206, v168
    v_mfma_f32_16x16x32_bf16 v[56:59], a[216:219], v[184:187], v[56:59]
    ds_read_b128 a[168:171], v216 offset:0
    v_add_f32 v206, v206, v169
    v_mfma_f32_16x16x32_bf16 v[60:63], a[220:223], v[184:187], v[60:63]
    s_waitcnt lgkmcnt(4)
    ds_read_b128 a[172:175], v217 offset:0
    v_add_f32 v206, v206, v170
    v_mfma_f32_16x16x32_bf16 v[64:67], a[192:195], v[188:191], v[64:67]
    v_add_f32 v206, v206, v171
    v_mfma_f32_16x16x32_bf16 v[68:71], a[196:199], v[188:191], v[68:71]
    buffer_load_dwordx4 v233, s[16:19], s27 offen offset:1024 nt lds
    v_mfma_f32_16x16x32_bf16 v[72:75], a[200:203], v[188:191], v[72:75]
    ds_read_b128 v[196:199], v227 offset:4096
    v_fma_f32 v172, v172, s24, -v212
    v_mfma_f32_16x16x32_bf16 v[76:79], a[204:207], v[188:191], v[76:79]
    ds_read_b128 a[176:179], v214 offset:256
    v_fma_f32 v173, v173, s24, -v212
    v_mfma_f32_16x16x32_bf16 v[80:83], a[208:211], v[188:191], v[80:83]
    v_exp_f32 v172, v172
    v_mfma_f32_16x16x32_bf16 v[84:87], a[212:215], v[188:191], v[84:87]
    ds_read_b128 a[180:183], v215 offset:256
    v_fma_f32 v174, v174, s24, -v212
    v_mfma_f32_16x16x32_bf16 v[88:91], a[216:219], v[188:191], v[88:91]
    v_exp_f32 v173, v173
    v_mfma_f32_16x16x32_bf16 v[92:95], a[220:223], v[188:191], v[92:95]
    s_waitcnt lgkmcnt(3)
    v_fma_f32 v175, v175, s24, -v212
    v_mfma_f32_16x16x32_bf16 v[96:99], a[192:195], v[192:195], v[96:99]
    v_exp_f32 v174, v174
    v_mfma_f32_16x16x32_bf16 v[100:103], a[196:199], v[192:195], v[100:103]
    ds_read_b128 a[184:187], v216 offset:256
    v_cvt_pk_bf16_f32 v202, v172, v173
    v_mfma_f32_16x16x32_bf16 v[104:107], a[200:203], v[192:195], v[104:107]
    v_exp_f32 v175, v175
    v_mfma_f32_16x16x32_bf16 v[108:111], a[204:207], v[192:195], v[108:111]
    buffer_load_dwordx4 v234, s[16:19], s27 offen offset:2048 nt lds
    v_mfma_f32_16x16x32_bf16 v[112:115], a[208:211], v[192:195], v[112:115]
    ds_read_b128 a[188:191], v217 offset:256
    v_cvt_pk_bf16_f32 v203, v174, v175
    v_mfma_f32_16x16x32_bf16 v[116:119], a[212:215], v[192:195], v[116:119]
    ds_write_b64 v226, v[202:203] offset:13312
    v_add_f32 v207, v207, v172
    v_mfma_f32_16x16x32_bf16 v[120:123], a[216:219], v[192:195], v[120:123]
    v_add_f32 v207, v207, v173
    v_mfma_f32_16x16x32_bf16 v[124:127], a[220:223], v[192:195], v[124:127]
    s_waitcnt lgkmcnt(3)
    v_add_f32 v207, v207, v174
    v_mfma_f32_16x16x32_bf16 v[128:131], a[192:195], v[196:199], v[128:131]
    v_add_f32 v207, v207, v175
    v_mfma_f32_16x16x32_bf16 v[132:135], a[196:199], v[196:199], v[132:135]
    buffer_load_dwordx4 v235, s[16:19], s27 offen offset:3072 nt lds
    v_mfma_f32_16x16x32_bf16 v[136:139], a[200:203], v[196:199], v[136:139]
    s_add_u32 s27, s27, 16384
    v_fma_f32 v176, v176, s24, -v213
    v_mfma_f32_16x16x32_bf16 v[140:143], a[204:207], v[196:199], v[140:143]
    s_and_b32 s27, s27, 0x7ffff
    v_fma_f32 v177, v177, s24, -v213
    v_mfma_f32_16x16x32_bf16 v[144:147], a[208:211], v[196:199], v[144:147]
    v_exp_f32 v176, v176
    v_mfma_f32_16x16x32_bf16 v[148:151], a[212:215], v[196:199], v[148:151]
    v_fma_f32 v178, v178, s24, -v213
    v_mfma_f32_16x16x32_bf16 v[152:155], a[216:219], v[196:199], v[152:155]
    v_exp_f32 v177, v177
    v_mfma_f32_16x16x32_bf16 v[156:159], a[220:223], v[196:199], v[156:159]
    v_fma_f32 v179, v179, s24, -v213
    v_mfma_f32_16x16x32_bf16 v[160:163], a[160:163], a[0:3], 0
    v_exp_f32 v178, v178
    v_mfma_f32_16x16x32_bf16 v[160:163], a[164:167], a[4:7], v[160:163]
    v_cvt_pk_bf16_f32 v200, v176, v177
    v_mfma_f32_16x16x32_bf16 v[160:163], a[168:171], a[8:11], v[160:163]
    v_exp_f32 v179, v179
    v_mfma_f32_16x16x32_bf16 v[160:163], a[172:175], a[12:15], v[160:163]
    v_mfma_f32_16x16x32_bf16 v[160:163], a[176:179], a[16:19], v[160:163]
    v_cvt_pk_bf16_f32 v201, v178, v179
    v_mfma_f32_16x16x32_bf16 v[160:163], a[180:183], a[20:23], v[160:163]
    s_waitcnt lgkmcnt(0)
    ds_write_b64 v226, v[200:201] offset:14336
    v_add_f32 v208, v208, v176
    v_mfma_f32_16x16x32_bf16 v[160:163], a[184:187], a[24:27], v[160:163]
    v_add_f32 v208, v208, v177
    v_mfma_f32_16x16x32_bf16 v[160:163], a[188:191], a[28:31], v[160:163]
    v_add_f32 v208, v208, v178
    v_mfma_f32_16x16x32_bf16 v[164:167], a[160:163], a[32:35], 0
    s_waitcnt vmcnt(16)
    v_add_f32 v208, v208, v179
    v_mfma_f32_16x16x32_bf16 v[164:167], a[164:167], a[36:39], v[164:167]
    s_barrier
    v_mfma_f32_16x16x32_bf16 v[164:167], a[168:171], a[40:43], v[164:167]
    ds_read_b64_tr_b16 a[192:193], v218 offset:49152
    v_fma_f32 v160, v160, s24, -v209
    v_mfma_f32_16x16x32_bf16 v[164:167], a[172:175], a[44:47], v[164:167]
    ds_read_b64_tr_b16 a[194:195], v218 offset:57344
    v_fma_f32 v161, v161, s24, -v209
    v_mfma_f32_16x16x32_bf16 v[164:167], a[176:179], a[48:51], v[164:167]
    v_exp_f32 v160, v160
    v_mfma_f32_16x16x32_bf16 v[164:167], a[180:183], a[52:55], v[164:167]
    ds_read_b64_tr_b16 a[196:197], v219 offset:49152
    v_fma_f32 v162, v162, s24, -v209
    v_mfma_f32_16x16x32_bf16 v[164:167], a[184:187], a[56:59], v[164:167]
    v_exp_f32 v161, v161
    v_mfma_f32_16x16x32_bf16 v[164:167], a[188:191], a[60:63], v[164:167]
    ds_read_b64_tr_b16 a[198:199], v219 offset:57344
    v_fma_f32 v163, v163, s24, -v209
    v_mfma_f32_16x16x32_bf16 v[168:171], a[160:163], a[64:67], 0
    v_exp_f32 v162, v162
    v_mfma_f32_16x16x32_bf16 v[168:171], a[164:167], a[68:71], v[168:171]
    ds_read_b128 v[180:183], v227 offset:10240
    v_cvt_pk_bf16_f32 v200, v160, v161
    v_mfma_f32_16x16x32_bf16 v[168:171], a[168:171], a[72:75], v[168:171]
    s_add_u32 m0, s25, 49152
    v_exp_f32 v163, v163
    v_mfma_f32_16x16x32_bf16 v[168:171], a[172:175], a[76:79], v[168:171]
    buffer_load_dwordx4 v228, s[12:15], s26 offen offset:0 nt lds
    v_mfma_f32_16x16x32_bf16 v[168:171], a[176:179], a[80:83], v[168:171]
    ds_read_b64_tr_b16 a[200:201], v220 offset:49152
    v_cvt_pk_bf16_f32 v201, v162, v163
    v_mfma_f32_16x16x32_bf16 v[168:171], a[180:183], a[84:87], v[168:171]
    ds_write_b64 v226, v[200:201] offset:0
    v_add_f32 v204, v204, v160
    v_mfma_f32_16x16x32_bf16 v[168:171], a[184:187], a[88:91], v[168:171]
    ds_read_b64_tr_b16 a[202:203], v220 offset:57344
    v_add_f32 v204, v204, v161
    v_mfma_f32_16x16x32_bf16 v[168:171], a[188:191], a[92:95], v[168:171]
    ds_read_b64_tr_b16 a[204:205], v221 offset:49152
    v_add_f32 v204, v204, v162
    v_mfma_f32_16x16x32_bf16 v[172:175], a[160:163], a[96:99], 0
    ds_read_b64_tr_b16 a[206:207], v221 offset:57344
    v_add_f32 v204, v204, v163
    v_mfma_f32_16x16x32_bf16 v[172:175], a[164:167], a[100:103], v[172:175]
    buffer_load_dwordx4 v229, s[12:15], s26 offen offset:1024 nt lds
    v_mfma_f32_16x16x32_bf16 v[172:175], a[168:171], a[104:107], v[172:175]
    ds_read_b64_tr_b16 a[208:209], v222 offset:49152
    v_fma_f32 v164, v164, s24, -v210
    v_mfma_f32_16x16x32_bf16 v[172:175], a[172:175], a[108:111], v[172:175]
    ds_read_b64_tr_b16 a[210:211], v222 offset:57344
    v_fma_f32 v165, v165, s24, -v210
    v_mfma_f32_16x16x32_bf16 v[172:175], a[176:179], a[112:115], v[172:175]
    v_exp_f32 v164, v164
    v_mfma_f32_16x16x32_bf16 v[172:175], a[180:183], a[116:119], v[172:175]
    ds_read_b64_tr_b16 a[212:213], v223 offset:49152
    v_fma_f32 v166, v166, s24, -v210
    v_mfma_f32_16x16x32_bf16 v[172:175], a[184:187], a[120:123], v[172:175]
    v_exp_f32 v165, v165
    v_mfma_f32_16x16x32_bf16 v[172:175], a[188:191], a[124:127], v[172:175]
    ds_read_b64_tr_b16 a[214:215], v223 offset:57344
    v_fma_f32 v167, v167, s24, -v210
    v_mfma_f32_16x16x32_bf16 v[176:179], a[160:163], a[128:131], 0
    v_exp_f32 v166, v166
    v_mfma_f32_16x16x32_bf16 v[176:179], a[164:167], a[132:135], v[176:179]
    ds_read_b64_tr_b16 a[216:217], v224 offset:49152
    v_cvt_pk_bf16_f32 v202, v164, v165
    v_mfma_f32_16x16x32_bf16 v[176:179], a[168:171], a[136:139], v[176:179]
    v_exp_f32 v167, v167
    v_mfma_f32_16x16x32_bf16 v[176:179], a[172:175], a[140:143], v[176:179]
    buffer_load_dwordx4 v230, s[12:15], s26 offen offset:2048 nt lds
    v_mfma_f32_16x16x32_bf16 v[176:179], a[176:179], a[144:147], v[176:179]
    ds_read_b64_tr_b16 a[218:219], v224 offset:57344
    v_cvt_pk_bf16_f32 v203, v166, v167
    v_mfma_f32_16x16x32_bf16 v[176:179], a[180:183], a[148:151], v[176:179]
    ds_write_b64 v226, v[202:203] offset:1024
    v_add_f32 v205, v205, v164
    v_mfma_f32_16x16x32_bf16 v[176:179], a[184:187], a[152:155], v[176:179]
    ds_read_b64_tr_b16 a[220:221], v225 offset:49152
    v_add_f32 v205, v205, v165
    v_mfma_f32_16x16x32_bf16 v[176:179], a[188:191], a[156:159], v[176:179]
    s_waitcnt lgkmcnt(4)
    ds_read_b64_tr_b16 a[222:223], v225 offset:57344
    v_add_f32 v205, v205, v166
    v_mfma_f32_16x16x32_bf16 v[0:3], a[192:195], v[180:183], v[0:3]
    ds_read_b128 v[184:187], v227 offset:11264
    v_add_f32 v205, v205, v167
    v_mfma_f32_16x16x32_bf16 v[4:7], a[196:199], v[180:183], v[4:7]
    buffer_load_dwordx4 v231, s[12:15], s26 offen offset:3072 nt lds
    v_mfma_f32_16x16x32_bf16 v[8:11], a[200:203], v[180:183], v[8:11]
    s_add_u32 s26, s26, 16384
    ds_read_b128 v[188:191], v227 offset:12288
    v_fma_f32 v168, v168, s24, -v211
    v_mfma_f32_16x16x32_bf16 v[12:15], a[204:207], v[180:183], v[12:15]
    s_and_b32 s26, s26, 0x7ffff
    v_fma_f32 v169, v169, s24, -v211
    v_mfma_f32_16x16x32_bf16 v[16:19], a[208:211], v[180:183], v[16:19]
    s_waitcnt vmcnt(16) lgkmcnt(2)
    v_exp_f32 v168, v168
    v_mfma_f32_16x16x32_bf16 v[20:23], a[212:215], v[180:183], v[20:23]
    s_barrier
    v_fma_f32 v170, v170, s24, -v211
    v_mfma_f32_16x16x32_bf16 v[24:27], a[216:219], v[180:183], v[24:27]
    v_exp_f32 v169, v169
    v_mfma_f32_16x16x32_bf16 v[28:31], a[220:223], v[180:183], v[28:31]
    s_waitcnt lgkmcnt(1)
    ds_read_b128 a[160:163], v214 offset:16384
    v_fma_f32 v171, v171, s24, -v211
    v_mfma_f32_16x16x32_bf16 v[32:35], a[192:195], v[184:187], v[32:35]
    v_exp_f32 v170, v170
    v_mfma_f32_16x16x32_bf16 v[36:39], a[196:199], v[184:187], v[36:39]
    ds_read_b128 a[164:167], v215 offset:16384
    v_cvt_pk_bf16_f32 v200, v168, v169
    v_mfma_f32_16x16x32_bf16 v[40:43], a[200:203], v[184:187], v[40:43]
    s_add_u32 m0, s25, 98304
    v_exp_f32 v171, v171
    v_mfma_f32_16x16x32_bf16 v[44:47], a[204:207], v[184:187], v[44:47]
    buffer_load_dwordx4 v232, s[16:19], s27 offen offset:0 nt lds
    v_mfma_f32_16x16x32_bf16 v[48:51], a[208:211], v[184:187], v[48:51]
    ds_read_b128 v[192:195], v227 offset:13312
    v_cvt_pk_bf16_f32 v201, v170, v171
    v_mfma_f32_16x16x32_bf16 v[52:55], a[212:215], v[184:187], v[52:55]
    ds_write_b64 v226, v[200:201] offset:2048
    v_add_f32 v206, v206, v168
    v_mfma_f32_16x16x32_bf16 v[56:59], a[216:219], v[184:187], v[56:59]
    ds_read_b128 a[168:171], v216 offset:16384
    v_add_f32 v206, v206, v169
    v_mfma_f32_16x16x32_bf16 v[60:63], a[220:223], v[184:187], v[60:63]
    s_waitcnt lgkmcnt(4)
    ds_read_b128 a[172:175], v217 offset:16384
    v_add_f32 v206, v206, v170
    v_mfma_f32_16x16x32_bf16 v[64:67], a[192:195], v[188:191], v[64:67]
    v_add_f32 v206, v206, v171
    v_mfma_f32_16x16x32_bf16 v[68:71], a[196:199], v[188:191], v[68:71]
    buffer_load_dwordx4 v233, s[16:19], s27 offen offset:1024 nt lds
    v_mfma_f32_16x16x32_bf16 v[72:75], a[200:203], v[188:191], v[72:75]
    ds_read_b128 v[196:199], v227 offset:14336
    v_fma_f32 v172, v172, s24, -v212
    v_mfma_f32_16x16x32_bf16 v[76:79], a[204:207], v[188:191], v[76:79]
    ds_read_b128 a[176:179], v214 offset:16640
    v_fma_f32 v173, v173, s24, -v212
    v_mfma_f32_16x16x32_bf16 v[80:83], a[208:211], v[188:191], v[80:83]
    v_exp_f32 v172, v172
    v_mfma_f32_16x16x32_bf16 v[84:87], a[212:215], v[188:191], v[84:87]
    ds_read_b128 a[180:183], v215 offset:16640
    v_fma_f32 v174, v174, s24, -v212
    v_mfma_f32_16x16x32_bf16 v[88:91], a[216:219], v[188:191], v[88:91]
    v_exp_f32 v173, v173
    v_mfma_f32_16x16x32_bf16 v[92:95], a[220:223], v[188:191], v[92:95]
    s_waitcnt lgkmcnt(3)
    v_fma_f32 v175, v175, s24, -v212
    v_mfma_f32_16x16x32_bf16 v[96:99], a[192:195], v[192:195], v[96:99]
    v_exp_f32 v174, v174
    v_mfma_f32_16x16x32_bf16 v[100:103], a[196:199], v[192:195], v[100:103]
    ds_read_b128 a[184:187], v216 offset:16640
    v_cvt_pk_bf16_f32 v202, v172, v173
    v_mfma_f32_16x16x32_bf16 v[104:107], a[200:203], v[192:195], v[104:107]
    v_exp_f32 v175, v175
    v_mfma_f32_16x16x32_bf16 v[108:111], a[204:207], v[192:195], v[108:111]
    buffer_load_dwordx4 v234, s[16:19], s27 offen offset:2048 nt lds
    v_mfma_f32_16x16x32_bf16 v[112:115], a[208:211], v[192:195], v[112:115]
    ds_read_b128 a[188:191], v217 offset:16640
    v_cvt_pk_bf16_f32 v203, v174, v175
    v_mfma_f32_16x16x32_bf16 v[116:119], a[212:215], v[192:195], v[116:119]
    ds_write_b64 v226, v[202:203] offset:3072
    v_add_f32 v207, v207, v172
    v_mfma_f32_16x16x32_bf16 v[120:123], a[216:219], v[192:195], v[120:123]
    v_add_f32 v207, v207, v173
    v_mfma_f32_16x16x32_bf16 v[124:127], a[220:223], v[192:195], v[124:127]
    s_waitcnt lgkmcnt(3)
    v_add_f32 v207, v207, v174
    v_mfma_f32_16x16x32_bf16 v[128:131], a[192:195], v[196:199], v[128:131]
    v_add_f32 v207, v207, v175
    v_mfma_f32_16x16x32_bf16 v[132:135], a[196:199], v[196:199], v[132:135]
    buffer_load_dwordx4 v235, s[16:19], s27 offen offset:3072 nt lds
    v_mfma_f32_16x16x32_bf16 v[136:139], a[200:203], v[196:199], v[136:139]
    s_add_u32 s27, s27, 16384
    v_fma_f32 v176, v176, s24, -v213
    v_mfma_f32_16x16x32_bf16 v[140:143], a[204:207], v[196:199], v[140:143]
    s_and_b32 s27, s27, 0x7ffff
    v_fma_f32 v177, v177, s24, -v213
    v_mfma_f32_16x16x32_bf16 v[144:147], a[208:211], v[196:199], v[144:147]
    v_exp_f32 v176, v176
    v_mfma_f32_16x16x32_bf16 v[148:151], a[212:215], v[196:199], v[148:151]
    v_fma_f32 v178, v178, s24, -v213
    v_mfma_f32_16x16x32_bf16 v[152:155], a[216:219], v[196:199], v[152:155]
    v_exp_f32 v177, v177
    v_mfma_f32_16x16x32_bf16 v[156:159], a[220:223], v[196:199], v[156:159]
    v_fma_f32 v179, v179, s24, -v213
    v_mfma_f32_16x16x32_bf16 v[160:163], a[160:163], a[0:3], 0
    v_exp_f32 v178, v178
    v_mfma_f32_16x16x32_bf16 v[160:163], a[164:167], a[4:7], v[160:163]
    v_cvt_pk_bf16_f32 v200, v176, v177
    v_mfma_f32_16x16x32_bf16 v[160:163], a[168:171], a[8:11], v[160:163]
    v_exp_f32 v179, v179
    v_mfma_f32_16x16x32_bf16 v[160:163], a[172:175], a[12:15], v[160:163]
    v_mfma_f32_16x16x32_bf16 v[160:163], a[176:179], a[16:19], v[160:163]
    v_cvt_pk_bf16_f32 v201, v178, v179
    v_mfma_f32_16x16x32_bf16 v[160:163], a[180:183], a[20:23], v[160:163]
    s_waitcnt lgkmcnt(0)
    ds_write_b64 v226, v[200:201] offset:4096
    v_add_f32 v208, v208, v176
    v_mfma_f32_16x16x32_bf16 v[160:163], a[184:187], a[24:27], v[160:163]
    v_add_f32 v208, v208, v177
    v_mfma_f32_16x16x32_bf16 v[160:163], a[188:191], a[28:31], v[160:163]
    v_add_f32 v208, v208, v178
    v_mfma_f32_16x16x32_bf16 v[164:167], a[160:163], a[32:35], 0
    s_waitcnt vmcnt(16)
    v_add_f32 v208, v208, v179
    v_mfma_f32_16x16x32_bf16 v[164:167], a[164:167], a[36:39], v[164:167]
    s_barrier
    v_mfma_f32_16x16x32_bf16 v[164:167], a[168:171], a[40:43], v[164:167]
    ds_read_b64_tr_b16 a[192:193], v218 offset:0
    v_fma_f32 v160, v160, s24, -v209
    v_mfma_f32_16x16x32_bf16 v[164:167], a[172:175], a[44:47], v[164:167]
    ds_read_b64_tr_b16 a[194:195], v218 offset:8192
    v_fma_f32 v161, v161, s24, -v209
    v_mfma_f32_16x16x32_bf16 v[164:167], a[176:179], a[48:51], v[164:167]
    v_exp_f32 v160, v160
    v_mfma_f32_16x16x32_bf16 v[164:167], a[180:183], a[52:55], v[164:167]
    ds_read_b64_tr_b16 a[196:197], v219 offset:0
    v_fma_f32 v162, v162, s24, -v209
    v_mfma_f32_16x16x32_bf16 v[164:167], a[184:187], a[56:59], v[164:167]
    v_exp_f32 v161, v161
    v_mfma_f32_16x16x32_bf16 v[164:167], a[188:191], a[60:63], v[164:167]
    ds_read_b64_tr_b16 a[198:199], v219 offset:8192
    v_fma_f32 v163, v163, s24, -v209
    v_mfma_f32_16x16x32_bf16 v[168:171], a[160:163], a[64:67], 0
    v_exp_f32 v162, v162
    v_mfma_f32_16x16x32_bf16 v[168:171], a[164:167], a[68:71], v[168:171]
    s_cmp_eq_u32 s28, 6
    s_cselect_b32 s14, 0, s14
    ds_read_b128 v[180:183], v227 offset:0
    v_cvt_pk_bf16_f32 v200, v160, v161
    v_mfma_f32_16x16x32_bf16 v[168:171], a[168:171], a[72:75], v[168:171]
    s_add_u32 m0, s25, 0
    v_exp_f32 v163, v163
    v_mfma_f32_16x16x32_bf16 v[168:171], a[172:175], a[76:79], v[168:171]
    buffer_load_dwordx4 v228, s[12:15], s26 offen offset:0 nt lds
    v_mfma_f32_16x16x32_bf16 v[168:171], a[176:179], a[80:83], v[168:171]
    ds_read_b64_tr_b16 a[200:201], v220 offset:0
    v_cvt_pk_bf16_f32 v201, v162, v163
    v_mfma_f32_16x16x32_bf16 v[168:171], a[180:183], a[84:87], v[168:171]
    ds_write_b64 v226, v[200:201] offset:10240
    v_add_f32 v204, v204, v160
    v_mfma_f32_16x16x32_bf16 v[168:171], a[184:187], a[88:91], v[168:171]
    ds_read_b64_tr_b16 a[202:203], v220 offset:8192
    v_add_f32 v204, v204, v161
    v_mfma_f32_16x16x32_bf16 v[168:171], a[188:191], a[92:95], v[168:171]
    ds_read_b64_tr_b16 a[204:205], v221 offset:0
    v_add_f32 v204, v204, v162
    v_mfma_f32_16x16x32_bf16 v[172:175], a[160:163], a[96:99], 0
    ds_read_b64_tr_b16 a[206:207], v221 offset:8192
    v_add_f32 v204, v204, v163
    v_mfma_f32_16x16x32_bf16 v[172:175], a[164:167], a[100:103], v[172:175]
    buffer_load_dwordx4 v229, s[12:15], s26 offen offset:1024 nt lds
    v_mfma_f32_16x16x32_bf16 v[172:175], a[168:171], a[104:107], v[172:175]
    ds_read_b64_tr_b16 a[208:209], v222 offset:0
    v_fma_f32 v164, v164, s24, -v210
    v_mfma_f32_16x16x32_bf16 v[172:175], a[172:175], a[108:111], v[172:175]
    ds_read_b64_tr_b16 a[210:211], v222 offset:8192
    v_fma_f32 v165, v165, s24, -v210
    v_mfma_f32_16x16x32_bf16 v[172:175], a[176:179], a[112:115], v[172:175]
    v_exp_f32 v164, v164
    v_mfma_f32_16x16x32_bf16 v[172:175], a[180:183], a[116:119], v[172:175]
    ds_read_b64_tr_b16 a[212:213], v223 offset:0
    v_fma_f32 v166, v166, s24, -v210
    v_mfma_f32_16x16x32_bf16 v[172:175], a[184:187], a[120:123], v[172:175]
    v_exp_f32 v165, v165
    v_mfma_f32_16x16x32_bf16 v[172:175], a[188:191], a[124:127], v[172:175]
    ds_read_b64_tr_b16 a[214:215], v223 offset:8192
    v_fma_f32 v167, v167, s24, -v210
    v_mfma_f32_16x16x32_bf16 v[176:179], a[160:163], a[128:131], 0
    v_exp_f32 v166, v166
    v_mfma_f32_16x16x32_bf16 v[176:179], a[164:167], a[132:135], v[176:179]
    ds_read_b64_tr_b16 a[216:217], v224 offset:0
    v_cvt_pk_bf16_f32 v202, v164, v165
    v_mfma_f32_16x16x32_bf16 v[176:179], a[168:171], a[136:139], v[176:179]
    v_exp_f32 v167, v167
    v_mfma_f32_16x16x32_bf16 v[176:179], a[172:175], a[140:143], v[176:179]
    buffer_load_dwordx4 v230, s[12:15], s26 offen offset:2048 nt lds
    v_mfma_f32_16x16x32_bf16 v[176:179], a[176:179], a[144:147], v[176:179]
    ds_read_b64_tr_b16 a[218:219], v224 offset:8192
    v_cvt_pk_bf16_f32 v203, v166, v167
    v_mfma_f32_16x16x32_bf16 v[176:179], a[180:183], a[148:151], v[176:179]
    ds_write_b64 v226, v[202:203] offset:11264
    v_add_f32 v205, v205, v164
    v_mfma_f32_16x16x32_bf16 v[176:179], a[184:187], a[152:155], v[176:179]
    ds_read_b64_tr_b16 a[220:221], v225 offset:0
    v_add_f32 v205, v205, v165
    v_mfma_f32_16x16x32_bf16 v[176:179], a[188:191], a[156:159], v[176:179]
    s_waitcnt lgkmcnt(4)
    ds_read_b64_tr_b16 a[222:223], v225 offset:8192
    v_add_f32 v205, v205, v166
    v_mfma_f32_16x16x32_bf16 v[0:3], a[192:195], v[180:183], v[0:3]
    ds_read_b128 v[184:187], v227 offset:1024
    v_add_f32 v205, v205, v167
    v_mfma_f32_16x16x32_bf16 v[4:7], a[196:199], v[180:183], v[4:7]
    buffer_load_dwordx4 v231, s[12:15], s26 offen offset:3072 nt lds
    v_mfma_f32_16x16x32_bf16 v[8:11], a[200:203], v[180:183], v[8:11]
    s_add_u32 s26, s26, 16384
    ds_read_b128 v[188:191], v227 offset:2048
    v_fma_f32 v168, v168, s24, -v211
    v_mfma_f32_16x16x32_bf16 v[12:15], a[204:207], v[180:183], v[12:15]
    s_and_b32 s26, s26, 0x7ffff
    v_fma_f32 v169, v169, s24, -v211
    v_mfma_f32_16x16x32_bf16 v[16:19], a[208:211], v[180:183], v[16:19]
    s_waitcnt vmcnt(16) lgkmcnt(2)
    v_exp_f32 v168, v168
    v_mfma_f32_16x16x32_bf16 v[20:23], a[212:215], v[180:183], v[20:23]
    s_barrier
    v_fma_f32 v170, v170, s24, -v211
    v_mfma_f32_16x16x32_bf16 v[24:27], a[216:219], v[180:183], v[24:27]
    v_exp_f32 v169, v169
    v_mfma_f32_16x16x32_bf16 v[28:31], a[220:223], v[180:183], v[28:31]
    s_waitcnt lgkmcnt(1)
    ds_read_b128 a[160:163], v214 offset:32768
    v_fma_f32 v171, v171, s24, -v211
    v_mfma_f32_16x16x32_bf16 v[32:35], a[192:195], v[184:187], v[32:35]
    v_exp_f32 v170, v170
    v_mfma_f32_16x16x32_bf16 v[36:39], a[196:199], v[184:187], v[36:39]
    ds_read_b128 a[164:167], v215 offset:32768
    v_cvt_pk_bf16_f32 v200, v168, v169
    v_mfma_f32_16x16x32_bf16 v[40:43], a[200:203], v[184:187], v[40:43]
    s_add_u32 m0, s25, 114688
    v_exp_f32 v171, v171
    v_mfma_f32_16x16x32_bf16 v[44:47], a[204:207], v[184:187], v[44:47]
    buffer_load_dwordx4 v232, s[16:19], s27 offen offset:0 nt lds
    v_mfma_f32_16x16x32_bf16 v[48:51], a[208:211], v[184:187], v[48:51]
    ds_read_b128 v[192:195], v227 offset:3072
    v_cvt_pk_bf16_f32 v201, v170, v171
    v_mfma_f32_16x16x32_bf16 v[52:55], a[212:215], v[184:187], v[52:55]
    ds_write_b64 v226, v[200:201] offset:12288
    v_add_f32 v206, v206, v168
    v_mfma_f32_16x16x32_bf16 v[56:59], a[216:219], v[184:187], v[56:59]
    ds_read_b128 a[168:171], v216 offset:32768
    v_add_f32 v206, v206, v169
    v_mfma_f32_16x16x32_bf16 v[60:63], a[220:223], v[184:187], v[60:63]
    s_waitcnt lgkmcnt(4)
    ds_read_b128 a[172:175], v217 offset:32768
    v_add_f32 v206, v206, v170
    v_mfma_f32_16x16x32_bf16 v[64:67], a[192:195], v[188:191], v[64:67]
    v_add_f32 v206, v206, v171
    v_mfma_f32_16x16x32_bf16 v[68:71], a[196:199], v[188:191], v[68:71]
    buffer_load_dwordx4 v233, s[16:19], s27 offen offset:1024 nt lds
    v_mfma_f32_16x16x32_bf16 v[72:75], a[200:203], v[188:191], v[72:75]
    ds_read_b128 v[196:199], v227 offset:4096
    v_fma_f32 v172, v172, s24, -v212
    v_mfma_f32_16x16x32_bf16 v[76:79], a[204:207], v[188:191], v[76:79]
    ds_read_b128 a[176:179], v214 offset:33024
    v_fma_f32 v173, v173, s24, -v212
    v_mfma_f32_16x16x32_bf16 v[80:83], a[208:211], v[188:191], v[80:83]
    v_exp_f32 v172, v172
    v_mfma_f32_16x16x32_bf16 v[84:87], a[212:215], v[188:191], v[84:87]
    ds_read_b128 a[180:183], v215 offset:33024
    v_fma_f32 v174, v174, s24, -v212
    v_mfma_f32_16x16x32_bf16 v[88:91], a[216:219], v[188:191], v[88:91]
    v_exp_f32 v173, v173
    v_mfma_f32_16x16x32_bf16 v[92:95], a[220:223], v[188:191], v[92:95]
    s_waitcnt lgkmcnt(3)
    v_fma_f32 v175, v175, s24, -v212
    v_mfma_f32_16x16x32_bf16 v[96:99], a[192:195], v[192:195], v[96:99]
    v_exp_f32 v174, v174
    v_mfma_f32_16x16x32_bf16 v[100:103], a[196:199], v[192:195], v[100:103]
    ds_read_b128 a[184:187], v216 offset:33024
    v_cvt_pk_bf16_f32 v202, v172, v173
    v_mfma_f32_16x16x32_bf16 v[104:107], a[200:203], v[192:195], v[104:107]
    v_exp_f32 v175, v175
    v_mfma_f32_16x16x32_bf16 v[108:111], a[204:207], v[192:195], v[108:111]
    buffer_load_dwordx4 v234, s[16:19], s27 offen offset:2048 nt lds
    v_mfma_f32_16x16x32_bf16 v[112:115], a[208:211], v[192:195], v[112:115]
    ds_read_b128 a[188:191], v217 offset:33024
    v_cvt_pk_bf16_f32 v203, v174, v175
    v_mfma_f32_16x16x32_bf16 v[116:119], a[212:215], v[192:195], v[116:119]
    ds_write_b64 v226, v[202:203] offset:13312
    v_add_f32 v207, v207, v172
    v_mfma_f32_16x16x32_bf16 v[120:123], a[216:219], v[192:195], v[120:123]
    v_add_f32 v207, v207, v173
    v_mfma_f32_16x16x32_bf16 v[124:127], a[220:223], v[192:195], v[124:127]
    s_waitcnt lgkmcnt(3)
    v_add_f32 v207, v207, v174
    v_mfma_f32_16x16x32_bf16 v[128:131], a[192:195], v[196:199], v[128:131]
    v_add_f32 v207, v207, v175
    v_mfma_f32_16x16x32_bf16 v[132:135], a[196:199], v[196:199], v[132:135]
    buffer_load_dwordx4 v235, s[16:19], s27 offen offset:3072 nt lds
    v_mfma_f32_16x16x32_bf16 v[136:139], a[200:203], v[196:199], v[136:139]
    s_add_u32 s27, s27, 16384
    v_fma_f32 v176, v176, s24, -v213
    v_mfma_f32_16x16x32_bf16 v[140:143], a[204:207], v[196:199], v[140:143]
    s_and_b32 s27, s27, 0x7ffff
    v_fma_f32 v177, v177, s24, -v213
    v_mfma_f32_16x16x32_bf16 v[144:147], a[208:211], v[196:199], v[144:147]
    v_exp_f32 v176, v176
    v_mfma_f32_16x16x32_bf16 v[148:151], a[212:215], v[196:199], v[148:151]
    v_fma_f32 v178, v178, s24, -v213
    v_mfma_f32_16x16x32_bf16 v[152:155], a[216:219], v[196:199], v[152:155]
    v_exp_f32 v177, v177
    v_mfma_f32_16x16x32_bf16 v[156:159], a[220:223], v[196:199], v[156:159]
    v_fma_f32 v179, v179, s24, -v213
    v_mfma_f32_16x16x32_bf16 v[160:163], a[160:163], a[0:3], 0
    v_exp_f32 v178, v178
    v_mfma_f32_16x16x32_bf16 v[160:163], a[164:167], a[4:7], v[160:163]
    v_cvt_pk_bf16_f32 v200, v176, v177
    v_mfma_f32_16x16x32_bf16 v[160:163], a[168:171], a[8:11], v[160:163]
    v_exp_f32 v179, v179
    v_mfma_f32_16x16x32_bf16 v[160:163], a[172:175], a[12:15], v[160:163]
    v_mfma_f32_16x16x32_bf16 v[160:163], a[176:179], a[16:19], v[160:163]
    v_cvt_pk_bf16_f32 v201, v178, v179
    v_mfma_f32_16x16x32_bf16 v[160:163], a[180:183], a[20:23], v[160:163]
    s_waitcnt lgkmcnt(0)
    ds_write_b64 v226, v[200:201] offset:14336
    v_add_f32 v208, v208, v176
    v_mfma_f32_16x16x32_bf16 v[160:163], a[184:187], a[24:27], v[160:163]
    v_add_f32 v208, v208, v177
    v_mfma_f32_16x16x32_bf16 v[160:163], a[188:191], a[28:31], v[160:163]
    v_add_f32 v208, v208, v178
    v_mfma_f32_16x16x32_bf16 v[164:167], a[160:163], a[32:35], 0
    s_waitcnt vmcnt(16)
    v_add_f32 v208, v208, v179
    v_mfma_f32_16x16x32_bf16 v[164:167], a[164:167], a[36:39], v[164:167]
    s_barrier
    v_mfma_f32_16x16x32_bf16 v[164:167], a[168:171], a[40:43], v[164:167]
    ds_read_b64_tr_b16 a[192:193], v218 offset:16384
    v_fma_f32 v160, v160, s24, -v209
    v_mfma_f32_16x16x32_bf16 v[164:167], a[172:175], a[44:47], v[164:167]
    ds_read_b64_tr_b16 a[194:195], v218 offset:24576
    v_fma_f32 v161, v161, s24, -v209
    v_mfma_f32_16x16x32_bf16 v[164:167], a[176:179], a[48:51], v[164:167]
    v_exp_f32 v160, v160
    v_mfma_f32_16x16x32_bf16 v[164:167], a[180:183], a[52:55], v[164:167]
    ds_read_b64_tr_b16 a[196:197], v219 offset:16384
    v_fma_f32 v162, v162, s24, -v209
    v_mfma_f32_16x16x32_bf16 v[164:167], a[184:187], a[56:59], v[164:167]
    v_exp_f32 v161, v161
    v_mfma_f32_16x16x32_bf16 v[164:167], a[188:191], a[60:63], v[164:167]
    ds_read_b64_tr_b16 a[198:199], v219 offset:24576
    v_fma_f32 v163, v163, s24, -v209
    v_mfma_f32_16x16x32_bf16 v[168:171], a[160:163], a[64:67], 0
    v_exp_f32 v162, v162
    v_mfma_f32_16x16x32_bf16 v[168:171], a[164:167], a[68:71], v[168:171]
    ds_read_b128 v[180:183], v227 offset:10240
    v_cvt_pk_bf16_f32 v200, v160, v161
    v_mfma_f32_16x16x32_bf16 v[168:171], a[168:171], a[72:75], v[168:171]
    s_add_u32 m0, s25, 16384
    v_exp_f32 v163, v163
    v_mfma_f32_16x16x32_bf16 v[168:171], a[172:175], a[76:79], v[168:171]
    buffer_load_dwordx4 v228, s[12:15], s26 offen offset:0 nt lds
    v_mfma_f32_16x16x32_bf16 v[168:171], a[176:179], a[80:83], v[168:171]
    ds_read_b64_tr_b16 a[200:201], v220 offset:16384
    v_cvt_pk_bf16_f32 v201, v162, v163
    v_mfma_f32_16x16x32_bf16 v[168:171], a[180:183], a[84:87], v[168:171]
    ds_write_b64 v226, v[200:201] offset:0
    v_add_f32 v204, v204, v160
    v_mfma_f32_16x16x32_bf16 v[168:171], a[184:187], a[88:91], v[168:171]
    ds_read_b64_tr_b16 a[202:203], v220 offset:24576
    v_add_f32 v204, v204, v161
    v_mfma_f32_16x16x32_bf16 v[168:171], a[188:191], a[92:95], v[168:171]
    ds_read_b64_tr_b16 a[204:205], v221 offset:16384
    v_add_f32 v204, v204, v162
    v_mfma_f32_16x16x32_bf16 v[172:175], a[160:163], a[96:99], 0
    ds_read_b64_tr_b16 a[206:207], v221 offset:24576
    v_add_f32 v204, v204, v163
    v_mfma_f32_16x16x32_bf16 v[172:175], a[164:167], a[100:103], v[172:175]
    buffer_load_dwordx4 v229, s[12:15], s26 offen offset:1024 nt lds
    v_mfma_f32_16x16x32_bf16 v[172:175], a[168:171], a[104:107], v[172:175]
    ds_read_b64_tr_b16 a[208:209], v222 offset:16384
    v_fma_f32 v164, v164, s24, -v210
    v_mfma_f32_16x16x32_bf16 v[172:175], a[172:175], a[108:111], v[172:175]
    ds_read_b64_tr_b16 a[210:211], v222 offset:24576
    v_fma_f32 v165, v165, s24, -v210
    v_mfma_f32_16x16x32_bf16 v[172:175], a[176:179], a[112:115], v[172:175]
    v_exp_f32 v164, v164
    v_mfma_f32_16x16x32_bf16 v[172:175], a[180:183], a[116:119], v[172:175]
    ds_read_b64_tr_b16 a[212:213], v223 offset:16384
    v_fma_f32 v166, v166, s24, -v210
    v_mfma_f32_16x16x32_bf16 v[172:175], a[184:187], a[120:123], v[172:175]
    v_exp_f32 v165, v165
    v_mfma_f32_16x16x32_bf16 v[172:175], a[188:191], a[124:127], v[172:175]
    ds_read_b64_tr_b16 a[214:215], v223 offset:24576
    v_fma_f32 v167, v167, s24, -v210
    v_mfma_f32_16x16x32_bf16 v[176:179], a[160:163], a[128:131], 0
    v_exp_f32 v166, v166
    v_mfma_f32_16x16x32_bf16 v[176:179], a[164:167], a[132:135], v[176:179]
    ds_read_b64_tr_b16 a[216:217], v224 offset:16384
    v_cvt_pk_bf16_f32 v202, v164, v165
    v_mfma_f32_16x16x32_bf16 v[176:179], a[168:171], a[136:139], v[176:179]
    v_exp_f32 v167, v167
    v_mfma_f32_16x16x32_bf16 v[176:179], a[172:175], a[140:143], v[176:179]
    buffer_load_dwordx4 v230, s[12:15], s26 offen offset:2048 nt lds
    v_mfma_f32_16x16x32_bf16 v[176:179], a[176:179], a[144:147], v[176:179]
    ds_read_b64_tr_b16 a[218:219], v224 offset:24576
    v_cvt_pk_bf16_f32 v203, v166, v167
    v_mfma_f32_16x16x32_bf16 v[176:179], a[180:183], a[148:151], v[176:179]
    ds_write_b64 v226, v[202:203] offset:1024
    v_add_f32 v205, v205, v164
    v_mfma_f32_16x16x32_bf16 v[176:179], a[184:187], a[152:155], v[176:179]
    ds_read_b64_tr_b16 a[220:221], v225 offset:16384
    v_add_f32 v205, v205, v165
    v_mfma_f32_16x16x32_bf16 v[176:179], a[188:191], a[156:159], v[176:179]
    s_waitcnt lgkmcnt(4)
    ds_read_b64_tr_b16 a[222:223], v225 offset:24576
    v_add_f32 v205, v205, v166
    v_mfma_f32_16x16x32_bf16 v[0:3], a[192:195], v[180:183], v[0:3]
    ds_read_b128 v[184:187], v227 offset:11264
    v_add_f32 v205, v205, v167
    v_mfma_f32_16x16x32_bf16 v[4:7], a[196:199], v[180:183], v[4:7]
    buffer_load_dwordx4 v231, s[12:15], s26 offen offset:3072 nt lds
    v_mfma_f32_16x16x32_bf16 v[8:11], a[200:203], v[180:183], v[8:11]
    s_add_u32 s26, s26, 16384
    ds_read_b128 v[188:191], v227 offset:12288
    v_fma_f32 v168, v168, s24, -v211
    v_mfma_f32_16x16x32_bf16 v[12:15], a[204:207], v[180:183], v[12:15]
    s_and_b32 s26, s26, 0x7ffff
    v_fma_f32 v169, v169, s24, -v211
    v_mfma_f32_16x16x32_bf16 v[16:19], a[208:211], v[180:183], v[16:19]
    s_waitcnt vmcnt(16) lgkmcnt(2)
    v_exp_f32 v168, v168
    v_mfma_f32_16x16x32_bf16 v[20:23], a[212:215], v[180:183], v[20:23]
    s_barrier
    v_fma_f32 v170, v170, s24, -v211
    v_mfma_f32_16x16x32_bf16 v[24:27], a[216:219], v[180:183], v[24:27]
    v_exp_f32 v169, v169
    v_mfma_f32_16x16x32_bf16 v[28:31], a[220:223], v[180:183], v[28:31]
    s_waitcnt lgkmcnt(1)
    ds_read_b128 a[160:163], v214 offset:49152
    v_fma_f32 v171, v171, s24, -v211
    v_mfma_f32_16x16x32_bf16 v[32:35], a[192:195], v[184:187], v[32:35]
    v_exp_f32 v170, v170
    v_mfma_f32_16x16x32_bf16 v[36:39], a[196:199], v[184:187], v[36:39]
    s_cmp_eq_u32 s28, 6
    s_cselect_b32 s18, 0, s18
    ds_read_b128 a[164:167], v215 offset:49152
    v_cvt_pk_bf16_f32 v200, v168, v169
    v_mfma_f32_16x16x32_bf16 v[40:43], a[200:203], v[184:187], v[40:43]
    s_add_u32 m0, s25, 65536
    v_exp_f32 v171, v171
    v_mfma_f32_16x16x32_bf16 v[44:47], a[204:207], v[184:187], v[44:47]
    buffer_load_dwordx4 v232, s[16:19], s27 offen offset:0 nt lds
    v_mfma_f32_16x16x32_bf16 v[48:51], a[208:211], v[184:187], v[48:51]
    ds_read_b128 v[192:195], v227 offset:13312
    v_cvt_pk_bf16_f32 v201, v170, v171
    v_mfma_f32_16x16x32_bf16 v[52:55], a[212:215], v[184:187], v[52:55]
    ds_write_b64 v226, v[200:201] offset:2048
    v_add_f32 v206, v206, v168
    v_mfma_f32_16x16x32_bf16 v[56:59], a[216:219], v[184:187], v[56:59]
    ds_read_b128 a[168:171], v216 offset:49152
    v_add_f32 v206, v206, v169
    v_mfma_f32_16x16x32_bf16 v[60:63], a[220:223], v[184:187], v[60:63]
    s_waitcnt lgkmcnt(4)
    ds_read_b128 a[172:175], v217 offset:49152
    v_add_f32 v206, v206, v170
    v_mfma_f32_16x16x32_bf16 v[64:67], a[192:195], v[188:191], v[64:67]
    v_add_f32 v206, v206, v171
    v_mfma_f32_16x16x32_bf16 v[68:71], a[196:199], v[188:191], v[68:71]
    buffer_load_dwordx4 v233, s[16:19], s27 offen offset:1024 nt lds
    v_mfma_f32_16x16x32_bf16 v[72:75], a[200:203], v[188:191], v[72:75]
    ds_read_b128 v[196:199], v227 offset:14336
    v_fma_f32 v172, v172, s24, -v212
    v_mfma_f32_16x16x32_bf16 v[76:79], a[204:207], v[188:191], v[76:79]
    ds_read_b128 a[176:179], v214 offset:49408
    v_fma_f32 v173, v173, s24, -v212
    v_mfma_f32_16x16x32_bf16 v[80:83], a[208:211], v[188:191], v[80:83]
    v_exp_f32 v172, v172
    v_mfma_f32_16x16x32_bf16 v[84:87], a[212:215], v[188:191], v[84:87]
    ds_read_b128 a[180:183], v215 offset:49408
    v_fma_f32 v174, v174, s24, -v212
    v_mfma_f32_16x16x32_bf16 v[88:91], a[216:219], v[188:191], v[88:91]
    v_exp_f32 v173, v173
    v_mfma_f32_16x16x32_bf16 v[92:95], a[220:223], v[188:191], v[92:95]
    s_waitcnt lgkmcnt(3)
    v_fma_f32 v175, v175, s24, -v212
    v_mfma_f32_16x16x32_bf16 v[96:99], a[192:195], v[192:195], v[96:99]
    v_exp_f32 v174, v174
    v_mfma_f32_16x16x32_bf16 v[100:103], a[196:199], v[192:195], v[100:103]
    ds_read_b128 a[184:187], v216 offset:49408
    v_cvt_pk_bf16_f32 v202, v172, v173
    v_mfma_f32_16x16x32_bf16 v[104:107], a[200:203], v[192:195], v[104:107]
    v_exp_f32 v175, v175
    v_mfma_f32_16x16x32_bf16 v[108:111], a[204:207], v[192:195], v[108:111]
    buffer_load_dwordx4 v234, s[16:19], s27 offen offset:2048 nt lds
    v_mfma_f32_16x16x32_bf16 v[112:115], a[208:211], v[192:195], v[112:115]
    ds_read_b128 a[188:191], v217 offset:49408
    v_cvt_pk_bf16_f32 v203, v174, v175
    v_mfma_f32_16x16x32_bf16 v[116:119], a[212:215], v[192:195], v[116:119]
    ds_write_b64 v226, v[202:203] offset:3072
    v_add_f32 v207, v207, v172
    v_mfma_f32_16x16x32_bf16 v[120:123], a[216:219], v[192:195], v[120:123]
    s_add_u32 s28, s28, 1
    v_add_f32 v207, v207, v173
    v_mfma_f32_16x16x32_bf16 v[124:127], a[220:223], v[192:195], v[124:127]
    s_waitcnt lgkmcnt(3)
    v_add_f32 v207, v207, v174
    v_mfma_f32_16x16x32_bf16 v[128:131], a[192:195], v[196:199], v[128:131]
    v_add_f32 v207, v207, v175
    v_mfma_f32_16x16x32_bf16 v[132:135], a[196:199], v[196:199], v[132:135]
    buffer_load_dwordx4 v235, s[16:19], s27 offen offset:3072 nt lds
    v_mfma_f32_16x16x32_bf16 v[136:139], a[200:203], v[196:199], v[136:139]
    s_add_u32 s27, s27, 16384
    v_fma_f32 v176, v176, s24, -v213
    v_mfma_f32_16x16x32_bf16 v[140:143], a[204:207], v[196:199], v[140:143]
    s_and_b32 s27, s27, 0x7ffff
    v_fma_f32 v177, v177, s24, -v213
    v_mfma_f32_16x16x32_bf16 v[144:147], a[208:211], v[196:199], v[144:147]
    v_exp_f32 v176, v176
    v_mfma_f32_16x16x32_bf16 v[148:151], a[212:215], v[196:199], v[148:151]
    s_cmp_lt_u32 s28, 7
    v_fma_f32 v178, v178, s24, -v213
    v_mfma_f32_16x16x32_bf16 v[152:155], a[216:219], v[196:199], v[152:155]
    v_exp_f32 v177, v177
    v_mfma_f32_16x16x32_bf16 v[156:159], a[220:223], v[196:199], v[156:159]
    v_fma_f32 v179, v179, s24, -v213
    s_cbranch_scc1 L_loop_n5
    v_mfma_f32_16x16x32_bf16 v[160:163], a[160:163], a[0:3], 0
    v_exp_f32 v178, v178
    v_mfma_f32_16x16x32_bf16 v[160:163], a[164:167], a[4:7], v[160:163]
    v_cvt_pk_bf16_f32 v200, v176, v177
    v_mfma_f32_16x16x32_bf16 v[160:163], a[168:171], a[8:11], v[160:163]
    v_exp_f32 v179, v179
    v_mfma_f32_16x16x32_bf16 v[160:163], a[172:175], a[12:15], v[160:163]
    v_mfma_f32_16x16x32_bf16 v[160:163], a[176:179], a[16:19], v[160:163]
    v_cvt_pk_bf16_f32 v201, v178, v179
    v_mfma_f32_16x16x32_bf16 v[160:163], a[180:183], a[20:23], v[160:163]
    s_waitcnt lgkmcnt(0)
    ds_write_b64 v226, v[200:201] offset:4096
    v_add_f32 v208, v208, v176
    v_mfma_f32_16x16x32_bf16 v[160:163], a[184:187], a[24:27], v[160:163]
    v_add_f32 v208, v208, v177
    v_mfma_f32_16x16x32_bf16 v[160:163], a[188:191], a[28:31], v[160:163]
    v_add_f32 v208, v208, v178
    v_mfma_f32_16x16x32_bf16 v[164:167], a[160:163], a[32:35], 0
    s_waitcnt vmcnt(16)
    v_add_f32 v208, v208, v179
    v_mfma_f32_16x16x32_bf16 v[164:167], a[164:167], a[36:39], v[164:167]
    s_barrier
    v_mfma_f32_16x16x32_bf16 v[164:167], a[168:171], a[40:43], v[164:167]
    ds_read_b64_tr_b16 a[192:193], v218 offset:32768
    v_fma_f32 v160, v160, s24, -v209
    v_mfma_f32_16x16x32_bf16 v[164:167], a[172:175], a[44:47], v[164:167]
    ds_read_b64_tr_b16 a[194:195], v218 offset:40960
    v_fma_f32 v161, v161, s24, -v209
    v_mfma_f32_16x16x32_bf16 v[164:167], a[176:179], a[48:51], v[164:167]
    v_exp_f32 v160, v160
    v_mfma_f32_16x16x32_bf16 v[164:167], a[180:183], a[52:55], v[164:167]
    ds_read_b64_tr_b16 a[196:197], v219 offset:32768
    v_fma_f32 v162, v162, s24, -v209
    v_mfma_f32_16x16x32_bf16 v[164:167], a[184:187], a[56:59], v[164:167]
    v_exp_f32 v161, v161
    v_mfma_f32_16x16x32_bf16 v[164:167], a[188:191], a[60:63], v[164:167]
    ds_read_b64_tr_b16 a[198:199], v219 offset:40960
    v_fma_f32 v163, v163, s24, -v209
    v_mfma_f32_16x16x32_bf16 v[168:171], a[160:163], a[64:67], 0
    v_exp_f32 v162, v162
    v_mfma_f32_16x16x32_bf16 v[168:171], a[164:167], a[68:71], v[168:171]
    ds_read_b128 v[180:183], v227 offset:0
    v_cvt_pk_bf16_f32 v200, v160, v161
    v_mfma_f32_16x16x32_bf16 v[168:171], a[168:171], a[72:75], v[168:171]
    v_exp_f32 v163, v163
    v_mfma_f32_16x16x32_bf16 v[168:171], a[172:175], a[76:79], v[168:171]
    ds_read_b64_tr_b16 a[200:201], v220 offset:32768
    v_mfma_f32_16x16x32_bf16 v[168:171], a[176:179], a[80:83], v[168:171]
    ds_read_b64_tr_b16 a[202:203], v220 offset:40960
    v_cvt_pk_bf16_f32 v201, v162, v163
    v_mfma_f32_16x16x32_bf16 v[168:171], a[180:183], a[84:87], v[168:171]
    ds_write_b64 v226, v[200:201] offset:10240
    v_add_f32 v204, v204, v160
    v_mfma_f32_16x16x32_bf16 v[168:171], a[184:187], a[88:91], v[168:171]
    ds_read_b64_tr_b16 a[204:205], v221 offset:32768
    v_add_f32 v204, v204, v161
    v_mfma_f32_16x16x32_bf16 v[168:171], a[188:191], a[92:95], v[168:171]
    ds_read_b64_tr_b16 a[206:207], v221 offset:40960
    v_add_f32 v204, v204, v162
    v_mfma_f32_16x16x32_bf16 v[172:175], a[160:163], a[96:99], 0
    ds_read_b64_tr_b16 a[208:209], v222 offset:32768
    v_add_f32 v204, v204, v163
    v_mfma_f32_16x16x32_bf16 v[172:175], a[164:167], a[100:103], v[172:175]
    ds_read_b64_tr_b16 a[210:211], v222 offset:40960
    v_mfma_f32_16x16x32_bf16 v[172:175], a[168:171], a[104:107], v[172:175]
    ds_read_b64_tr_b16 a[212:213], v223 offset:32768
    v_fma_f32 v164, v164, s24, -v210
    v_mfma_f32_16x16x32_bf16 v[172:175], a[172:175], a[108:111], v[172:175]
    ds_read_b64_tr_b16 a[214:215], v223 offset:40960
    v_fma_f32 v165, v165, s24, -v210
    v_mfma_f32_16x16x32_bf16 v[172:175], a[176:179], a[112:115], v[172:175]
    v_exp_f32 v164, v164
    v_mfma_f32_16x16x32_bf16 v[172:175], a[180:183], a[116:119], v[172:175]
    ds_read_b64_tr_b16 a[216:217], v224 offset:32768
    v_fma_f32 v166, v166, s24, -v210
    v_mfma_f32_16x16x32_bf16 v[172:175], a[184:187], a[120:123], v[172:175]
    v_exp_f32 v165, v165
    v_mfma_f32_16x16x32_bf16 v[172:175], a[188:191], a[124:127], v[172:175]
    ds_read_b64_tr_b16 a[218:219], v224 offset:40960
    v_fma_f32 v167, v167, s24, -v210
    v_mfma_f32_16x16x32_bf16 v[176:179], a[160:163], a[128:131], 0
    v_exp_f32 v166, v166
    v_mfma_f32_16x16x32_bf16 v[176:179], a[164:167], a[132:135], v[176:179]
    ds_read_b64_tr_b16 a[220:221], v225 offset:32768
    v_cvt_pk_bf16_f32 v202, v164, v165
    v_mfma_f32_16x16x32_bf16 v[176:179], a[168:171], a[136:139], v[176:179]
    v_exp_f32 v167, v167
    v_mfma_f32_16x16x32_bf16 v[176:179], a[172:175], a[140:143], v[176:179]
    ds_read_b64_tr_b16 a[222:223], v225 offset:40960
    v_mfma_f32_16x16x32_bf16 v[176:179], a[176:179], a[144:147], v[176:179]
    ds_read_b128 v[184:187], v227 offset:1024
    v_cvt_pk_bf16_f32 v203, v166, v167
    v_mfma_f32_16x16x32_bf16 v[176:179], a[180:183], a[148:151], v[176:179]
    ds_write_b64 v226, v[202:203] offset:11264
    v_add_f32 v205, v205, v164
    v_mfma_f32_16x16x32_bf16 v[176:179], a[184:187], a[152:155], v[176:179]
    v_add_f32 v205, v205, v165
    v_mfma_f32_16x16x32_bf16 v[176:179], a[188:191], a[156:159], v[176:179]
    s_waitcnt lgkmcnt(4)
    v_add_f32 v205, v205, v166
    v_mfma_f32_16x16x32_bf16 v[0:3], a[192:195], v[180:183], v[0:3]
    v_add_f32 v205, v205, v167
    v_mfma_f32_16x16x32_bf16 v[4:7], a[196:199], v[180:183], v[4:7]
    v_mfma_f32_16x16x32_bf16 v[8:11], a[200:203], v[180:183], v[8:11]
    ds_read_b128 v[188:191], v227 offset:2048
    v_fma_f32 v168, v168, s24, -v211
    v_mfma_f32_16x16x32_bf16 v[12:15], a[204:207], v[180:183], v[12:15]
    v_fma_f32 v169, v169, s24, -v211
    v_mfma_f32_16x16x32_bf16 v[16:19], a[208:211], v[180:183], v[16:19]
    s_waitcnt lgkmcnt(1)
    v_exp_f32 v168, v168
    v_mfma_f32_16x16x32_bf16 v[20:23], a[212:215], v[180:183], v[20:23]
    s_barrier
    v_fma_f32 v170, v170, s24, -v211
    v_mfma_f32_16x16x32_bf16 v[24:27], a[216:219], v[180:183], v[24:27]
    v_exp_f32 v169, v169
    v_mfma_f32_16x16x32_bf16 v[28:31], a[220:223], v[180:183], v[28:31]
    v_fma_f32 v171, v171, s24, -v211
    v_mfma_f32_16x16x32_bf16 v[32:35], a[192:195], v[184:187], v[32:35]
    v_exp_f32 v170, v170
    v_mfma_f32_16x16x32_bf16 v[36:39], a[196:199], v[184:187], v[36:39]
    v_cvt_pk_bf16_f32 v200, v168, v169
    v_mfma_f32_16x16x32_bf16 v[40:43], a[200:203], v[184:187], v[40:43]
    v_exp_f32 v171, v171
    v_mfma_f32_16x16x32_bf16 v[44:47], a[204:207], v[184:187], v[44:47]
    ds_read_b128 v[192:195], v227 offset:3072
    v_mfma_f32_16x16x32_bf16 v[48:51], a[208:211], v[184:187], v[48:51]
    v_cvt_pk_bf16_f32 v201, v170, v171
    v_mfma_f32_16x16x32_bf16 v[52:55], a[212:215], v[184:187], v[52:55]
    ds_write_b64 v226, v[200:201] offset:12288
    v_add_f32 v206, v206, v168
    v_mfma_f32_16x16x32_bf16 v[56:59], a[216:219], v[184:187], v[56:59]
    v_add_f32 v206, v206, v169
    v_mfma_f32_16x16x32_bf16 v[60:63], a[220:223], v[184:187], v[60:63]
    s_waitcnt lgkmcnt(2)
    v_add_f32 v206, v206, v170
    v_mfma_f32_16x16x32_bf16 v[64:67], a[192:195], v[188:191], v[64:67]
    v_add_f32 v206, v206, v171
    v_mfma_f32_16x16x32_bf16 v[68:71], a[196:199], v[188:191], v[68:71]
    v_mfma_f32_16x16x32_bf16 v[72:75], a[200:203], v[188:191], v[72:75]
    ds_read_b128 v[196:199], v227 offset:4096
    v_fma_f32 v172, v172, s24, -v212
    v_mfma_f32_16x16x32_bf16 v[76:79], a[204:207], v[188:191], v[76:79]
    v_fma_f32 v173, v173, s24, -v212
    v_mfma_f32_16x16x32_bf16 v[80:83], a[208:211], v[188:191], v[80:83]
    v_exp_f32 v172, v172
    v_mfma_f32_16x16x32_bf16 v[84:87], a[212:215], v[188:191], v[84:87]
    v_fma_f32 v174, v174, s24, -v212
    v_mfma_f32_16x16x32_bf16 v[88:91], a[216:219], v[188:191], v[88:91]
    v_exp_f32 v173, v173
    v_mfma_f32_16x16x32_bf16 v[92:95], a[220:223], v[188:191], v[92:95]
    s_waitcnt lgkmcnt(1)
    v_fma_f32 v175, v175, s24, -v212
    v_mfma_f32_16x16x32_bf16 v[96:99], a[192:195], v[192:195], v[96:99]
    v_exp_f32 v174, v174
    v_mfma_f32_16x16x32_bf16 v[100:103], a[196:199], v[192:195], v[100:103]
    v_cvt_pk_bf16_f32 v202, v172, v173
    v_mfma_f32_16x16x32_bf16 v[104:107], a[200:203], v[192:195], v[104:107]
    v_exp_f32 v175, v175
    v_mfma_f32_16x16x32_bf16 v[108:111], a[204:207], v[192:195], v[108:111]
    v_mfma_f32_16x16x32_bf16 v[112:115], a[208:211], v[192:195], v[112:115]
    v_cvt_pk_bf16_f32 v203, v174, v175
    v_mfma_f32_16x16x32_bf16 v[116:119], a[212:215], v[192:195], v[116:119]
    ds_write_b64 v226, v[202:203] offset:13312
    v_add_f32 v207, v207, v172
    v_mfma_f32_16x16x32_bf16 v[120:123], a[216:219], v[192:195], v[120:123]
    v_add_f32 v207, v207, v173
    v_mfma_f32_16x16x32_bf16 v[124:127], a[220:223], v[192:195], v[124:127]
    s_waitcnt lgkmcnt(1)
    v_add_f32 v207, v207, v174
    v_mfma_f32_16x16x32_bf16 v[128:131], a[192:195], v[196:199], v[128:131]
    v_add_f32 v207, v207, v175
    v_mfma_f32_16x16x32_bf16 v[132:135], a[196:199], v[196:199], v[132:135]
    v_mfma_f32_16x16x32_bf16 v[136:139], a[200:203], v[196:199], v[136:139]
    v_fma_f32 v176, v176, s24, -v213
    v_mfma_f32_16x16x32_bf16 v[140:143], a[204:207], v[196:199], v[140:143]
    v_fma_f32 v177, v177, s24, -v213
    v_mfma_f32_16x16x32_bf16 v[144:147], a[208:211], v[196:199], v[144:147]
    v_exp_f32 v176, v176
    v_mfma_f32_16x16x32_bf16 v[148:151], a[212:215], v[196:199], v[148:151]
    v_fma_f32 v178, v178, s24, -v213
    v_mfma_f32_16x16x32_bf16 v[152:155], a[216:219], v[196:199], v[152:155]
    v_exp_f32 v177, v177
    v_mfma_f32_16x16x32_bf16 v[156:159], a[220:223], v[196:199], v[156:159]
    v_fma_f32 v179, v179, s24, -v213
    v_exp_f32 v178, v178
    s_nop 0
    v_cvt_pk_bf16_f32 v200, v176, v177
    v_exp_f32 v179, v179
    s_nop 0
    v_cvt_pk_bf16_f32 v201, v178, v179
    ds_write_b64 v226, v[200:201] offset:14336
    v_add_f32 v208, v208, v176
    v_add_f32 v208, v208, v177
    v_add_f32 v208, v208, v178
    v_add_f32 v208, v208, v179
    ds_write_b32 v237, v204 offset:0
    ds_write_b32 v237, v205 offset:256
    ds_write_b32 v237, v206 offset:512
    ds_write_b32 v237, v207 offset:768
    ds_write_b32 v237, v208 offset:1024
    v_add_f32 v160, v204, v205
    v_mov_b32 v161, 0x4b800000
    v_add_f32 v160, v160, v206
    v_add_f32 v160, v160, v207
    v_add_f32 v160, v160, v208
    s_lshl_b32 s35, s30, 2
    s_add_u32 s35, s35, 156672
    v_cmp_nle_f32 vcc, v160, v161
    v_mov_b32 v163, s35
    s_nop 2
    s_cmp_lg_u64 vcc, 0
    s_cselect_b32 s34, 1, 0
    v_mov_b32 v162, s34
    ds_write_b32 v163, v162
    s_waitcnt vmcnt(0) lgkmcnt(0)
    s_barrier
    ds_read_b64_tr_b16 a[192:193], v218 offset:49152
    ds_read_b64_tr_b16 a[194:195], v218 offset:57344
    ds_read_b64_tr_b16 a[196:197], v219 offset:49152
    ds_read_b64_tr_b16 a[198:199], v219 offset:57344
    ds_read_b128 v[180:183], v227 offset:10240
    ds_read_b64_tr_b16 a[200:201], v220 offset:49152
    ds_read_b64_tr_b16 a[202:203], v220 offset:57344
    ds_read_b64_tr_b16 a[204:205], v221 offset:49152
    ds_read_b64_tr_b16 a[206:207], v221 offset:57344
    ds_read_b64_tr_b16 a[208:209], v222 offset:49152
    ds_read_b64_tr_b16 a[210:211], v222 offset:57344
    ds_read_b64_tr_b16 a[212:213], v223 offset:49152
    ds_read_b64_tr_b16 a[214:215], v223 offset:57344
    ds_read_b64_tr_b16 a[216:217], v224 offset:49152
    ds_read_b64_tr_b16 a[218:219], v224 offset:57344
    ds_read_b64_tr_b16 a[220:221], v225 offset:49152
    ds_read_b64_tr_b16 a[222:223], v225 offset:57344
    v_mov_b32 v163, 156672
    ds_read_b128 v[160:163], v163
    ds_read_b32 v251, v248 offset:0
    ds_read_b32 v252, v248 offset:256
    ds_read_b32 v253, v248 offset:512
    ds_read_b32 v254, v248 offset:768
    ds_read_b32 v255, v248 offset:1024
    ds_read_b128 v[184:187], v227 offset:11264
    ds_read_b128 v[188:191], v227 offset:12288
    ds_read_b128 v[192:195], v227 offset:13312
    ds_read_b128 v[196:199], v227 offset:14336
    v_and_b32 v216, 15, v236
    v_lshrrev_b32 v217, 4, v236
    s_lshl_b32 s36, s30, 14
    v_mul_u32_u24 v214, 272, v216
    v_and_b32 v215, 1, v217
    v_lshl_add_u32 v214, v215, 5, v214
    v_lshrrev_b32 v215, 1, v217
    v_lshl_add_u32 v214, v215, 4, v214
    v_add_u32 v214, s36, v214
    v_mul_u32_u24 v215, 272, v217
    v_lshl_add_u32 v215, v216, 4, v215
    v_add_u32 v215, s36, v215
    s_waitcnt lgkmcnt(15)
    v_mfma_f32_16x16x32_bf16 v[0:3], a[192:195], v[180:183], v[0:3]
    v_mfma_f32_16x16x32_bf16 v[4:7], a[196:199], v[180:183], v[4:7]
    s_waitcnt lgkmcnt(15)
    v_mfma_f32_16x16x32_bf16 v[8:11], a[200:203], v[180:183], v[8:11]
    s_waitcnt lgkmcnt(15)
    v_mfma_f32_16x16x32_bf16 v[12:15], a[204:207], v[180:183], v[12:15]
    s_waitcnt lgkmcnt(15)
    v_mfma_f32_16x16x32_bf16 v[16:19], a[208:211], v[180:183], v[16:19]
    s_waitcnt lgkmcnt(4)
    v_or_b32 v160, v160, v161
    v_add_f32 v204, v204, v251
    v_add_f32 v205, v205, v252
    v_add_f32 v206, v206, v253
    v_add_f32 v207, v207, v254
    v_add_f32 v208, v208, v255
    v_or3_b32 v160, v160, v162, v163
    s_nop 0
    v_readfirstlane_b32 s34, v160
    v_mov_b32 v251, v204
    v_mov_b32 v252, v205
    v_mov_b32 v253, v206
    s_waitcnt lgkmcnt(14)
    v_mfma_f32_16x16x32_bf16 v[20:23], a[212:215], v[180:183], v[20:23]
    v_mov_b32 v254, v207
    v_mov_b32 v255, v208
    s_nop 0
    v_permlane32_swap_b32 v251, v204
    v_permlane32_swap_b32 v252, v205
    v_permlane32_swap_b32 v253, v206
    v_permlane32_swap_b32 v254, v207
    v_permlane32_swap_b32 v255, v208
    v_add_f32 v204, v204, v251
    v_add_f32 v205, v205, v252
    v_add_f32 v206, v206, v253
    v_add_f32 v207, v207, v254
    v_add_f32 v208, v208, v255
    s_waitcnt lgkmcnt(12)
    v_mfma_f32_16x16x32_bf16 v[24:27], a[216:219], v[180:183], v[24:27]
    v_mov_b32 v251, v204
    v_mov_b32 v252, v205
    v_mov_b32 v253, v206
    v_mov_b32 v254, v207
    v_mov_b32 v255, v208
    s_nop 0
    v_permlane16_swap_b32 v251, v204
    v_permlane16_swap_b32 v252, v205
    v_permlane16_swap_b32 v253, v206
    v_permlane16_swap_b32 v254, v207
    v_permlane16_swap_b32 v255, v208
    v_add_f32 v204, v204, v251
    v_add_f32 v205, v205, v252
    s_waitcnt lgkmcnt(10)
    v_mfma_f32_16x16x32_bf16 v[28:31], a[220:223], v[180:183], v[28:31]
    v_add_f32 v206, v206, v253
    v_add_f32 v207, v207, v254
    v_add_f32 v208, v208, v255
    s_andn2_b32 s34, s34, s29
    s_cmp_lg_u32 s34, 0
    s_cbranch_scc1 L_fallback_n5
    v_rcp_f32 v238, v204
    v_rcp_f32 v240, v205
    v_rcp_f32 v242, v206
    v_rcp_f32 v244, v207
    v_rcp_f32 v246, v208
    s_waitcnt lgkmcnt(0)
    v_mfma_f32_16x16x32_bf16 v[32:35], a[192:195], v[184:187], v[32:35]
    v_mfma_f32_16x16x32_bf16 v[36:39], a[196:199], v[184:187], v[36:39]
    v_mfma_f32_16x16x32_bf16 v[40:43], a[200:203], v[184:187], v[40:43]
    v_pk_mul_f32 v[0:1], v[0:1], v[238:239] op_sel_hi:[1,0]
    v_pk_mul_f32 v[2:3], v[2:3], v[238:239] op_sel_hi:[1,0]
    v_pk_mul_f32 v[4:5], v[4:5], v[238:239] op_sel_hi:[1,0]
    v_pk_mul_f32 v[6:7], v[6:7], v[238:239] op_sel_hi:[1,0]
    v_cvt_pk_bf16_f32 v200, v0, v1
    v_cvt_pk_bf16_f32 v201, v2, v3
    v_cvt_pk_bf16_f32 v202, v4, v5
    v_cvt_pk_bf16_f32 v203, v6, v7
    v_mfma_f32_16x16x32_bf16 v[44:47], a[204:207], v[184:187], v[44:47]
    v_pk_mul_f32 v[8:9], v[8:9], v[238:239] op_sel_hi:[1,0]
    v_pk_mul_f32 v[10:11], v[10:11], v[238:239] op_sel_hi:[1,0]
    v_pk_mul_f32 v[12:13], v[12:13], v[238:239] op_sel_hi:[1,0]
    v_pk_mul_f32 v[14:15], v[14:15], v[238:239] op_sel_hi:[1,0]
    v_permlane16_swap_b32 v200, v202
    v_permlane16_swap_b32 v201, v203
    ds_write_b128 v214, v[200:203] offset:0
    v_cvt_pk_bf16_f32 v228, v8, v9
    v_mfma_f32_16x16x32_bf16 v[48:51], a[208:211], v[184:187], v[48:51]
    v_cvt_pk_bf16_f32 v229, v10, v11
    v_cvt_pk_bf16_f32 v230, v12, v13
    v_cvt_pk_bf16_f32 v231, v14, v15
    v_pk_mul_f32 v[16:17], v[16:17], v[238:239] op_sel_hi:[1,0]
    v_pk_mul_f32 v[18:19], v[18:19], v[238:239] op_sel_hi:[1,0]
    v_pk_mul_f32 v[20:21], v[20:21], v[238:239] op_sel_hi:[1,0]
    v_pk_mul_f32 v[22:23], v[22:23], v[238:239] op_sel_hi:[1,0]
    v_permlane16_swap_b32 v228, v230
    v_mfma_f32_16x16x32_bf16 v[52:55], a[212:215], v[184:187], v[52:55]
    v_permlane16_swap_b32 v229, v231
    ds_write_b128 v214, v[228:231] offset:64
    v_cvt_pk_bf16_f32 v232, v16, v17
    v_cvt_pk_bf16_f32 v233, v18, v19
    v_cvt_pk_bf16_f32 v234, v20, v21
    v_cvt_pk_bf16_f32 v235, v22, v23
    v_pk_mul_f32 v[24:25], v[24:25], v[238:239] op_sel_hi:[1,0]
    v_mfma_f32_16x16x32_bf16 v[56:59], a[216:219], v[184:187], v[56:59]
    v_pk_mul_f32 v[26:27], v[26:27], v[238:239] op_sel_hi:[1,0]
    v_pk_mul_f32 v[28:29], v[28:29], v[238:239] op_sel_hi:[1,0]
    v_pk_mul_f32 v[30:31], v[30:31], v[238:239] op_sel_hi:[1,0]
    v_permlane16_swap_b32 v232, v234
    v_permlane16_swap_b32 v233, v235
    ds_write_b128 v214, v[232:235] offset:128
    v_cvt_pk_bf16_f32 v200, v24, v25
    v_mfma_f32_16x16x32_bf16 v[60:63], a[220:223], v[184:187], v[60:63]
    v_cvt_pk_bf16_f32 v201, v26, v27
    v_cvt_pk_bf16_f32 v202, v28, v29
    v_cvt_pk_bf16_f32 v203, v30, v31
    s_nop 1
    v_permlane16_swap_b32 v200, v202
    v_permlane16_swap_b32 v201, v203
    ds_write_b128 v214, v[200:203] offset:192
    v_mfma_f32_16x16x32_bf16 v[64:67], a[192:195], v[188:191], v[64:67]
    v_mfma_f32_16x16x32_bf16 v[68:71], a[196:199], v[188:191], v[68:71]
    v_mfma_f32_16x16x32_bf16 v[72:75], a[200:203], v[188:191], v[72:75]
    ds_read_b128 v[160:163], v215 offset:0
    ds_read_b128 v[164:167], v215 offset:1088
    ds_read_b128 v[168:171], v215 offset:2176
    ds_read_b128 v[172:175], v215 offset:3264
    v_pk_mul_f32 v[32:33], v[32:33], v[240:241] op_sel_hi:[1,0]
    v_pk_mul_f32 v[34:35], v[34:35], v[240:241] op_sel_hi:[1,0]
    v_pk_mul_f32 v[36:37], v[36:37], v[240:241] op_sel_hi:[1,0]
    v_pk_mul_f32 v[38:39], v[38:39], v[240:241] op_sel_hi:[1,0]
    v_cvt_pk_bf16_f32 v228, v32, v33
    v_mfma_f32_16x16x32_bf16 v[76:79], a[204:207], v[188:191], v[76:79]
    v_cvt_pk_bf16_f32 v229, v34, v35
    v_cvt_pk_bf16_f32 v230, v36, v37
    v_cvt_pk_bf16_f32 v231, v38, v39
    v_pk_mul_f32 v[40:41], v[40:41], v[240:241] op_sel_hi:[1,0]
    v_pk_mul_f32 v[42:43], v[42:43], v[240:241] op_sel_hi:[1,0]
    v_pk_mul_f32 v[44:45], v[44:45], v[240:241] op_sel_hi:[1,0]
    v_pk_mul_f32 v[46:47], v[46:47], v[240:241] op_sel_hi:[1,0]
    v_permlane16_swap_b32 v228, v230
    v_permlane16_swap_b32 v229, v231
    v_mfma_f32_16x16x32_bf16 v[80:83], a[208:211], v[188:191], v[80:83]
    ds_write_b128 v214, v[228:231] offset:4352
    s_waitcnt lgkmcnt(1)
    buffer_store_dwordx4 v[160:163], v249, s[20:23], s44 offen offset:0 nt
    v_cvt_pk_bf16_f32 v232, v40, v41
    v_cvt_pk_bf16_f32 v233, v42, v43
    v_cvt_pk_bf16_f32 v234, v44, v45
    v_cvt_pk_bf16_f32 v235, v46, v47
    v_pk_mul_f32 v[48:49], v[48:49], v[240:241] op_sel_hi:[1,0]
    v_pk_mul_f32 v[50:51], v[50:51], v[240:241] op_sel_hi:[1,0]
    v_mfma_f32_16x16x32_bf16 v[84:87], a[212:215], v[188:191], v[84:87]
    v_pk_mul_f32 v[52:53], v[52:53], v[240:241] op_sel_hi:[1,0]
    v_pk_mul_f32 v[54:55], v[54:55], v[240:241] op_sel_hi:[1,0]
    v_permlane16_swap_b32 v232, v234
    v_permlane16_swap_b32 v233, v235
    ds_write_b128 v214, v[232:235] offset:4416
    buffer_store_dwordx4 v[164:167], v249, s[20:23], s44 offen offset:2048 nt
    v_cvt_pk_bf16_f32 v200, v48, v49
    v_cvt_pk_bf16_f32 v201, v50, v51
    v_cvt_pk_bf16_f32 v202, v52, v53
    v_mfma_f32_16x16x32_bf16 v[88:91], a[216:219], v[188:191], v[88:91]
    v_cvt_pk_bf16_f32 v203, v54, v55
    v_pk_mul_f32 v[56:57], v[56:57], v[240:241] op_sel_hi:[1,0]
    v_pk_mul_f32 v[58:59], v[58:59], v[240:241] op_sel_hi:[1,0]
    v_pk_mul_f32 v[60:61], v[60:61], v[240:241] op_sel_hi:[1,0]
    v_pk_mul_f32 v[62:63], v[62:63], v[240:241] op_sel_hi:[1,0]
    v_permlane16_swap_b32 v200, v202
    v_permlane16_swap_b32 v201, v203
    ds_write_b128 v214, v[200:203] offset:4480
    buffer_store_dwordx4 v[168:171], v250, s[20:23], s44 offen offset:0 nt
    v_mfma_f32_16x16x32_bf16 v[92:95], a[220:223], v[188:191], v[92:95]
    v_cvt_pk_bf16_f32 v228, v56, v57
    v_cvt_pk_bf16_f32 v229, v58, v59
    v_cvt_pk_bf16_f32 v230, v60, v61
    v_cvt_pk_bf16_f32 v231, v62, v63
    s_nop 1
    v_permlane16_swap_b32 v228, v230
    v_permlane16_swap_b32 v229, v231
    ds_write_b128 v214, v[228:231] offset:4544
    buffer_store_dwordx4 v[172:175], v250, s[20:23], s44 offen offset:2048 nt
    v_mfma_f32_16x16x32_bf16 v[96:99], a[192:195], v[192:195], v[96:99]
    v_mfma_f32_16x16x32_bf16 v[100:103], a[196:199], v[192:195], v[100:103]
    v_mfma_f32_16x16x32_bf16 v[104:107], a[200:203], v[192:195], v[104:107]
    ds_read_b128 v[160:163], v215 offset:4352
    ds_read_b128 v[164:167], v215 offset:5440
    ds_read_b128 v[168:171], v215 offset:6528
    ds_read_b128 v[172:175], v215 offset:7616
    v_pk_mul_f32 v[64:65], v[64:65], v[242:243] op_sel_hi:[1,0]
    v_pk_mul_f32 v[66:67], v[66:67], v[242:243] op_sel_hi:[1,0]
    v_pk_mul_f32 v[68:69], v[68:69], v[242:243] op_sel_hi:[1,0]
    v_pk_mul_f32 v[70:71], v[70:71], v[242:243] op_sel_hi:[1,0]
    v_cvt_pk_bf16_f32 v232, v64, v65
    v_mfma_f32_16x16x32_bf16 v[108:111], a[204:207], v[192:195], v[108:111]
    v_cvt_pk_bf16_f32 v233, v66, v67
    v_cvt_pk_bf16_f32 v234, v68, v69
    v_cvt_pk_bf16_f32 v235, v70, v71
    v_pk_mul_f32 v[72:73], v[72:73], v[242:243] op_sel_hi:[1,0]
    v_pk_mul_f32 v[74:75], v[74:75], v[242:243] op_sel_hi:[1,0]
    v_pk_mul_f32 v[76:77], v[76:77], v[242:243] op_sel_hi:[1,0]
    v_pk_mul_f32 v[78:79], v[78:79], v[242:243] op_sel_hi:[1,0]
    v_permlane16_swap_b32 v232, v234
    v_permlane16_swap_b32 v233, v235
    v_mfma_f32_16x16x32_bf16 v[112:115], a[208:211], v[192:195], v[112:115]
    ds_write_b128 v214, v[232:235] offset:8704
    s_waitcnt lgkmcnt(1)
    buffer_store_dwordx4 v[160:163], v249, s[20:23], s45 offen offset:0 nt
    v_cvt_pk_bf16_f32 v200, v72, v73
    v_cvt_pk_bf16_f32 v201, v74, v75
    v_cvt_pk_bf16_f32 v202, v76, v77
    v_cvt_pk_bf16_f32 v203, v78, v79
    v_pk_mul_f32 v[80:81], v[80:81], v[242:243] op_sel_hi:[1,0]
    v_pk_mul_f32 v[82:83], v[82:83], v[242:243] op_sel_hi:[1,0]
    v_mfma_f32_16x16x32_bf16 v[116:119], a[212:215], v[192:195], v[116:119]
    v_pk_mul_f32 v[84:85], v[84:85], v[242:243] op_sel_hi:[1,0]
    v_pk_mul_f32 v[86:87], v[86:87], v[242:243] op_sel_hi:[1,0]
    v_permlane16_swap_b32 v200, v202
    v_permlane16_swap_b32 v201, v203
    ds_write_b128 v214, v[200:203] offset:8768
    buffer_store_dwordx4 v[164:167], v249, s[20:23], s45 offen offset:2048 nt
    v_cvt_pk_bf16_f32 v228, v80, v81
    v_cvt_pk_bf16_f32 v229, v82, v83
    v_cvt_pk_bf16_f32 v230, v84, v85
    v_mfma_f32_16x16x32_bf16 v[120:123], a[216:219], v[192:195], v[120:123]
    v_cvt_pk_bf16_f32 v231, v86, v87
    v_pk_mul_f32 v[88:89], v[88:89], v[242:243] op_sel_hi:[1,0]
    v_pk_mul_f32 v[90:91], v[90:91], v[242:243] op_sel_hi:[1,0]
    v_pk_mul_f32 v[92:93], v[92:93], v[242:243] op_sel_hi:[1,0]
    v_pk_mul_f32 v[94:95], v[94:95], v[242:243] op_sel_hi:[1,0]
    v_permlane16_swap_b32 v228, v230
    v_permlane16_swap_b32 v229, v231
    ds_write_b128 v214, v[228:231] offset:8832
    buffer_store_dwordx4 v[168:171], v250, s[20:23], s45 offen offset:0 nt
    v_mfma_f32_16x16x32_bf16 v[124:127], a[220:223], v[192:195], v[124:127]
    v_cvt_pk_bf16_f32 v232, v88, v89
    v_cvt_pk_bf16_f32 v233, v90, v91
    v_cvt_pk_bf16_f32 v234, v92, v93
    v_cvt_pk_bf16_f32 v235, v94, v95
    s_nop 1
    v_permlane16_swap_b32 v232, v234
    v_permlane16_swap_b32 v233, v235
    ds_write_b128 v214, v[232:235] offset:8896
    buffer_store_dwordx4 v[172:175], v250, s[20:23], s45 offen offset:2048 nt
    v_mfma_f32_16x16x32_bf16 v[128:131], a[192:195], v[196:199], v[128:131]
    v_mfma_f32_16x16x32_bf16 v[132:135], a[196:199], v[196:199], v[132:135]
    v_mfma_f32_16x16x32_bf16 v[136:139], a[200:203], v[196:199], v[136:139]
    ds_read_b128 v[160:163], v215 offset:8704
    ds_read_b128 v[164:167], v215 offset:9792
    ds_read_b128 v[168:171], v215 offset:10880
    ds_read_b128 v[172:175], v215 offset:11968
    v_pk_mul_f32 v[96:97], v[96:97], v[244:245] op_sel_hi:[1,0]
    v_pk_mul_f32 v[98:99], v[98:99], v[244:245] op_sel_hi:[1,0]
    v_pk_mul_f32 v[100:101], v[100:101], v[244:245] op_sel_hi:[1,0]
    v_pk_mul_f32 v[102:103], v[102:103], v[244:245] op_sel_hi:[1,0]
    v_cvt_pk_bf16_f32 v200, v96, v97
    v_mfma_f32_16x16x32_bf16 v[140:143], a[204:207], v[196:199], v[140:143]
    v_cvt_pk_bf16_f32 v201, v98, v99
    v_cvt_pk_bf16_f32 v202, v100, v101
    v_cvt_pk_bf16_f32 v203, v102, v103
    v_pk_mul_f32 v[104:105], v[104:105], v[244:245] op_sel_hi:[1,0]
    v_pk_mul_f32 v[106:107], v[106:107], v[244:245] op_sel_hi:[1,0]
    v_pk_mul_f32 v[108:109], v[108:109], v[244:245] op_sel_hi:[1,0]
    v_pk_mul_f32 v[110:111], v[110:111], v[244:245] op_sel_hi:[1,0]
    v_permlane16_swap_b32 v200, v202
    v_permlane16_swap_b32 v201, v203
    v_mfma_f32_16x16x32_bf16 v[144:147], a[208:211], v[196:199], v[144:147]
    ds_write_b128 v214, v[200:203] offset:0
    s_waitcnt lgkmcnt(1)
    buffer_store_dwordx4 v[160:163], v249, s[20:23], s46 offen offset:0 nt
    v_cvt_pk_bf16_f32 v228, v104, v105
    v_cvt_pk_bf16_f32 v229, v106, v107
    v_cvt_pk_bf16_f32 v230, v108, v109
    v_cvt_pk_bf16_f32 v231, v110, v111
    v_pk_mul_f32 v[112:113], v[112:113], v[244:245] op_sel_hi:[1,0]
    v_pk_mul_f32 v[114:115], v[114:115], v[244:245] op_sel_hi:[1,0]
    v_mfma_f32_16x16x32_bf16 v[148:151], a[212:215], v[196:199], v[148:151]
    v_pk_mul_f32 v[116:117], v[116:117], v[244:245] op_sel_hi:[1,0]
    v_pk_mul_f32 v[118:119], v[118:119], v[244:245] op_sel_hi:[1,0]
    v_permlane16_swap_b32 v228, v230
    v_permlane16_swap_b32 v229, v231
    ds_write_b128 v214, v[228:231] offset:64
    buffer_store_dwordx4 v[164:167], v249, s[20:23], s46 offen offset:2048 nt
    v_cvt_pk_bf16_f32 v232, v112, v113
    v_cvt_pk_bf16_f32 v233, v114, v115
    v_cvt_pk_bf16_f32 v234, v116, v117
    v_mfma_f32_16x16x32_bf16 v[152:155], a[216:219], v[196:199], v[152:155]
    v_cvt_pk_bf16_f32 v235, v118, v119
    v_pk_mul_f32 v[120:121], v[120:121], v[244:245] op_sel_hi:[1,0]
    v_pk_mul_f32 v[122:123], v[122:123], v[244:245] op_sel_hi:[1,0]
    v_pk_mul_f32 v[124:125], v[124:125], v[244:245] op_sel_hi:[1,0]
    v_pk_mul_f32 v[126:127], v[126:127], v[244:245] op_sel_hi:[1,0]
    v_permlane16_swap_b32 v232, v234
    v_permlane16_swap_b32 v233, v235
    ds_write_b128 v214, v[232:235] offset:128
    buffer_store_dwordx4 v[168:171], v250, s[20:23], s46 offen offset:0 nt
    v_mfma_f32_16x16x32_bf16 v[156:159], a[220:223], v[196:199], v[156:159]
    v_cvt_pk_bf16_f32 v200, v120, v121
    v_cvt_pk_bf16_f32 v201, v122, v123
    v_cvt_pk_bf16_f32 v202, v124, v125
    v_cvt_pk_bf16_f32 v203, v126, v127
    s_nop 1
    v_permlane16_swap_b32 v200, v202
    v_permlane16_swap_b32 v201, v203
    ds_write_b128 v214, v[200:203] offset:192
    buffer_store_dwordx4 v[172:175], v250, s[20:23], s46 offen offset:2048 nt
    s_nop 7
    ds_read_b128 v[160:163], v215 offset:0
    ds_read_b128 v[164:167], v215 offset:1088
    ds_read_b128 v[168:171], v215 offset:2176
    ds_read_b128 v[172:175], v215 offset:3264
    v_pk_mul_f32 v[128:129], v[128:129], v[246:247] op_sel_hi:[1,0]
    v_pk_mul_f32 v[130:131], v[130:131], v[246:247] op_sel_hi:[1,0]
    v_pk_mul_f32 v[132:133], v[132:133], v[246:247] op_sel_hi:[1,0]
    v_pk_mul_f32 v[134:135], v[134:135], v[246:247] op_sel_hi:[1,0]
    v_cvt_pk_bf16_f32 v228, v128, v129
    v_cvt_pk_bf16_f32 v229, v130, v131
    v_cvt_pk_bf16_f32 v230, v132, v133
    v_cvt_pk_bf16_f32 v231, v134, v135
    v_pk_mul_f32 v[136:137], v[136:137], v[246:247] op_sel_hi:[1,0]
    v_pk_mul_f32 v[138:139], v[138:139], v[246:247] op_sel_hi:[1,0]
    v_pk_mul_f32 v[140:141], v[140:141], v[246:247] op_sel_hi:[1,0]
    v_pk_mul_f32 v[142:143], v[142:143], v[246:247] op_sel_hi:[1,0]
    v_permlane16_swap_b32 v228, v230
    v_permlane16_swap_b32 v229, v231
    ds_write_b128 v214, v[228:231] offset:4352
    s_waitcnt lgkmcnt(1)
    buffer_store_dwordx4 v[160:163], v249, s[20:23], s47 offen offset:0 nt
    v_cvt_pk_bf16_f32 v232, v136, v137
    v_cvt_pk_bf16_f32 v233, v138, v139
    v_cvt_pk_bf16_f32 v234, v140, v141
    v_cvt_pk_bf16_f32 v235, v142, v143
    v_pk_mul_f32 v[144:145], v[144:145], v[246:247] op_sel_hi:[1,0]
    v_pk_mul_f32 v[146:147], v[146:147], v[246:247] op_sel_hi:[1,0]
    v_pk_mul_f32 v[148:149], v[148:149], v[246:247] op_sel_hi:[1,0]
    v_pk_mul_f32 v[150:151], v[150:151], v[246:247] op_sel_hi:[1,0]
    v_permlane16_swap_b32 v232, v234
    v_permlane16_swap_b32 v233, v235
    ds_write_b128 v214, v[232:235] offset:4416
    buffer_store_dwordx4 v[164:167], v249, s[20:23], s47 offen offset:2048 nt
    v_cvt_pk_bf16_f32 v200, v144, v145
    v_cvt_pk_bf16_f32 v201, v146, v147
    v_cvt_pk_bf16_f32 v202, v148, v149
    v_cvt_pk_bf16_f32 v203, v150, v151
    v_pk_mul_f32 v[152:153], v[152:153], v[246:247] op_sel_hi:[1,0]
    v_pk_mul_f32 v[154:155], v[154:155], v[246:247] op_sel_hi:[1,0]
    v_pk_mul_f32 v[156:157], v[156:157], v[246:247] op_sel_hi:[1,0]
    v_pk_mul_f32 v[158:159], v[158:159], v[246:247] op_sel_hi:[1,0]
    v_permlane16_swap_b32 v200, v202
    v_permlane16_swap_b32 v201, v203
    ds_write_b128 v214, v[200:203] offset:4480
    buffer_store_dwordx4 v[168:171], v250, s[20:23], s47 offen offset:0 nt
    v_cvt_pk_bf16_f32 v228, v152, v153
    v_cvt_pk_bf16_f32 v229, v154, v155
    v_cvt_pk_bf16_f32 v230, v156, v157
    v_cvt_pk_bf16_f32 v231, v158, v159
    s_nop 1
    v_permlane16_swap_b32 v228, v230
    v_permlane16_swap_b32 v229, v231
    ds_write_b128 v214, v[228:231] offset:4544
    buffer_store_dwordx4 v[172:175], v250, s[20:23], s47 offen offset:2048 nt
    ds_read_b128 v[160:163], v215 offset:4352
    ds_read_b128 v[164:167], v215 offset:5440
    ds_read_b128 v[168:171], v215 offset:6528
    ds_read_b128 v[172:175], v215 offset:7616
    s_waitcnt lgkmcnt(0)
    buffer_store_dwordx4 v[160:163], v249, s[20:23], s48 offen offset:0 nt
    buffer_store_dwordx4 v[164:167], v249, s[20:23], s48 offen offset:2048 nt
    buffer_store_dwordx4 v[168:171], v250, s[20:23], s48 offen offset:0 nt
    buffer_store_dwordx4 v[172:175], v250, s[20:23], s48 offen offset:2048 nt
    s_endpgm
L_fallback_n5:
    s_waitcnt vmcnt(0) lgkmcnt(0)
    s_barrier
    v_and_b32 v251, 15, v236
    v_lshrrev_b32 v252, 4, v236
    s_lshl_b32 s34, s32, 13
    v_lshlrev_b32 v253, 9, v251
    v_add_u32 v253, s34, v253
    v_add_u32 v254, 0, v252
    v_xor_b32 v254, v254, v251
    v_lshl_add_u32 v214, v254, 4, v253
    v_add_u32 v254, 4, v252
    v_xor_b32 v254, v254, v251
    v_lshl_add_u32 v215, v254, 4, v253
    v_add_u32 v254, 8, v252
    v_xor_b32 v254, v254, v251
    v_lshl_add_u32 v216, v254, 4, v253
    v_add_u32 v254, 12, v252
    v_xor_b32 v254, v254, v251
    v_lshl_add_u32 v217, v254, 4, v253
    v_lshrrev_b32 v251, 5, v236
    v_and_b32 v252, 31, v236
    s_lshl_b32 s34, s30, 3
    v_add_u32 v254, s34, v251
    v_lshlrev_b32 v253, 9, v254
    v_add_u32 v255, 0, v254
    v_and_b32 v255, 15, v255
    v_xor_b32 v255, v255, v252
    v_lshl_add_u32 v228, v255, 4, v253
    v_add_u32 v255, 0, v251
    v_lshlrev_b32 v255, 1, v255
    v_xor_b32 v255, v255, v252
    v_lshl_add_u32 v232, v255, 4, v253
    v_add_u32 v255, 2, v254
    v_and_b32 v255, 15, v255
    v_xor_b32 v255, v255, v252
    v_lshl_add_u32 v229, v255, 4, v253
    v_add_u32 v255, 2, v251
    v_lshlrev_b32 v255, 1, v255
    v_xor_b32 v255, v255, v252
    v_lshl_add_u32 v233, v255, 4, v253
    v_add_u32 v255, 4, v254
    v_and_b32 v255, 15, v255
    v_xor_b32 v255, v255, v252
    v_lshl_add_u32 v230, v255, 4, v253
    v_add_u32 v255, 4, v251
    v_lshlrev_b32 v255, 1, v255
    v_xor_b32 v255, v255, v252
    v_lshl_add_u32 v234, v255, 4, v253
    v_add_u32 v255, 6, v254
    v_and_b32 v255, 15, v255
    v_xor_b32 v255, v255, v252
    v_lshl_add_u32 v231, v255, 4, v253
    v_add_u32 v255, 6, v251
    v_lshlrev_b32 v255, 1, v255
    v_xor_b32 v255, v255, v252
    v_lshl_add_u32 v235, v255, 4, v253
    v_mov_b32 v209, 0xff800000
    v_mov_b32 v210, 0xff800000
    v_mov_b32 v211, 0xff800000
    v_mov_b32 v212, 0xff800000
    v_mov_b32 v213, 0xff800000
    s_mov_b32 s26, 0
    s_mov_b32 s28, 0
    s_mov_b32 s14, 524288
L_fbloop_n5:
    s_add_u32 m0, s25, 0
    s_nop 0
    buffer_load_dwordx4 v228, s[12:15], s26 offen offset:0 nt lds
    buffer_load_dwordx4 v229, s[12:15], s26 offen offset:1024 nt lds
    buffer_load_dwordx4 v230, s[12:15], s26 offen offset:2048 nt lds
    buffer_load_dwordx4 v231, s[12:15], s26 offen offset:3072 nt lds
    s_add_u32 s26, s26, 16384
    s_and_b32 s26, s26, 0x7ffff
    s_waitcnt vmcnt(0)
    s_barrier
    ds_read_b128 a[160:163], v214 offset:0
    ds_read_b128 a[164:167], v215 offset:0
    ds_read_b128 a[168:171], v216 offset:0
    ds_read_b128 a[172:175], v217 offset:0
    ds_read_b128 a[176:179], v214 offset:256
    ds_read_b128 a[180:183], v215 offset:256
    ds_read_b128 a[184:187], v216 offset:256
    ds_read_b128 a[188:191], v217 offset:256
    s_waitcnt lgkmcnt(0)
    s_barrier
    v_mfma_f32_16x16x32_bf16 v[160:163], a[160:163], a[0:3], 0
    v_mfma_f32_16x16x32_bf16 v[160:163], a[164:167], a[4:7], v[160:163]
    v_mfma_f32_16x16x32_bf16 v[160:163], a[168:171], a[8:11], v[160:163]
    v_mfma_f32_16x16x32_bf16 v[160:163], a[172:175], a[12:15], v[160:163]
    v_mfma_f32_16x16x32_bf16 v[160:163], a[176:179], a[16:19], v[160:163]
    v_mfma_f32_16x16x32_bf16 v[160:163], a[180:183], a[20:23], v[160:163]
    v_mfma_f32_16x16x32_bf16 v[160:163], a[184:187], a[24:27], v[160:163]
    v_mfma_f32_16x16x32_bf16 v[160:163], a[188:191], a[28:31], v[160:163]
    v_mfma_f32_16x16x32_bf16 v[164:167], a[160:163], a[32:35], 0
    v_mfma_f32_16x16x32_bf16 v[164:167], a[164:167], a[36:39], v[164:167]
    v_mfma_f32_16x16x32_bf16 v[164:167], a[168:171], a[40:43], v[164:167]
    v_mfma_f32_16x16x32_bf16 v[164:167], a[172:175], a[44:47], v[164:167]
    v_mfma_f32_16x16x32_bf16 v[164:167], a[176:179], a[48:51], v[164:167]
    v_mfma_f32_16x16x32_bf16 v[164:167], a[180:183], a[52:55], v[164:167]
    v_mfma_f32_16x16x32_bf16 v[164:167], a[184:187], a[56:59], v[164:167]
    v_mfma_f32_16x16x32_bf16 v[164:167], a[188:191], a[60:63], v[164:167]
    v_mfma_f32_16x16x32_bf16 v[168:171], a[160:163], a[64:67], 0
    v_mfma_f32_16x16x32_bf16 v[168:171], a[164:167], a[68:71], v[168:171]
    v_mfma_f32_16x16x32_bf16 v[168:171], a[168:171], a[72:75], v[168:171]
    v_mfma_f32_16x16x32_bf16 v[168:171], a[172:175], a[76:79], v[168:171]
    v_mfma_f32_16x16x32_bf16 v[168:171], a[176:179], a[80:83], v[168:171]
    v_mfma_f32_16x16x32_bf16 v[168:171], a[180:183], a[84:87], v[168:171]
    v_mfma_f32_16x16x32_bf16 v[168:171], a[184:187], a[88:91], v[168:171]
    v_mfma_f32_16x16x32_bf16 v[168:171], a[188:191], a[92:95], v[168:171]
    v_mfma_f32_16x16x32_bf16 v[172:175], a[160:163], a[96:99], 0
    v_mfma_f32_16x16x32_bf16 v[172:175], a[164:167], a[100:103], v[172:175]
    v_mfma_f32_16x16x32_bf16 v[172:175], a[168:171], a[104:107], v[172:175]
    v_mfma_f32_16x16x32_bf16 v[172:175], a[172:175], a[108:111], v[172:175]
    v_mfma_f32_16x16x32_bf16 v[172:175], a[176:179], a[112:115], v[172:175]
    v_mfma_f32_16x16x32_bf16 v[172:175], a[180:183], a[116:119], v[172:175]
    v_mfma_f32_16x16x32_bf16 v[172:175], a[184:187], a[120:123], v[172:175]
    v_mfma_f32_16x16x32_bf16 v[172:175], a[188:191], a[124:127], v[172:175]
    v_mfma_f32_16x16x32_bf16 v[176:179], a[160:163], a[128:131], 0
    v_mfma_f32_16x16x32_bf16 v[176:179], a[164:167], a[132:135], v[176:179]
    v_mfma_f32_16x16x32_bf16 v[176:179], a[168:171], a[136:139], v[176:179]
    v_mfma_f32_16x16x32_bf16 v[176:179], a[172:175], a[140:143], v[176:179]
    v_mfma_f32_16x16x32_bf16 v[176:179], a[176:179], a[144:147], v[176:179]
    v_mfma_f32_16x16x32_bf16 v[176:179], a[180:183], a[148:151], v[176:179]
    v_mfma_f32_16x16x32_bf16 v[176:179], a[184:187], a[152:155], v[176:179]
    v_mfma_f32_16x16x32_bf16 v[176:179], a[188:191], a[156:159], v[176:179]
    s_nop 7
    v_max3_f32 v209, v209, v160, v161
    v_max3_f32 v209, v209, v162, v163
    v_max3_f32 v210, v210, v164, v165
    v_max3_f32 v210, v210, v166, v167
    v_max3_f32 v211, v211, v168, v169
    v_max3_f32 v211, v211, v170, v171
    v_max3_f32 v212, v212, v172, v173
    v_max3_f32 v212, v212, v174, v175
    v_max3_f32 v213, v213, v176, v177
    v_max3_f32 v213, v213, v178, v179
    s_add_u32 s28, s28, 1
    s_cmp_lt_u32 s28, 32
    s_cbranch_scc1 L_fbloop_n5
    v_mov_b32 v251, v209
    v_mov_b32 v252, v210
    v_mov_b32 v253, v211
    v_mov_b32 v254, v212
    v_mov_b32 v255, v213
    s_nop 0
    v_permlane32_swap_b32 v251, v209
    v_permlane32_swap_b32 v252, v210
    v_permlane32_swap_b32 v253, v211
    v_permlane32_swap_b32 v254, v212
    v_permlane32_swap_b32 v255, v213
    v_max_f32 v209, v209, v251
    v_max_f32 v210, v210, v252
    v_max_f32 v211, v211, v253
    v_max_f32 v212, v212, v254
    v_max_f32 v213, v213, v255
    v_mov_b32 v251, v209
    v_mov_b32 v252, v210
    v_mov_b32 v253, v211
    v_mov_b32 v254, v212
    v_mov_b32 v255, v213
    s_nop 0
    v_permlane16_swap_b32 v251, v209
    v_permlane16_swap_b32 v252, v210
    v_permlane16_swap_b32 v253, v211
    v_permlane16_swap_b32 v254, v212
    v_permlane16_swap_b32 v255, v213
    v_max_f32 v209, v209, v251
    v_max_f32 v210, v210, v252
    v_max_f32 v211, v211, v253
    v_max_f32 v212, v212, v254
    v_max_f32 v213, v213, v255
    ds_write_b32 v237, v209 offset:0
    ds_write_b32 v237, v210 offset:256
    ds_write_b32 v237, v211 offset:512
    ds_write_b32 v237, v212 offset:768
    ds_write_b32 v237, v213 offset:1024
    s_waitcnt lgkmcnt(0)
    s_barrier
    ds_read_b32 v251, v248 offset:0
    ds_read_b32 v252, v248 offset:256
    ds_read_b32 v253, v248 offset:512
    ds_read_b32 v254, v248 offset:768
    ds_read_b32 v255, v248 offset:1024
    s_waitcnt lgkmcnt(0)
    v_max_f32 v209, v209, v251
    v_max_f32 v210, v210, v252
    v_max_f32 v211, v211, v253
    v_max_f32 v212, v212, v254
    v_max_f32 v213, v213, v255
    v_mul_f32 v209, s24, v209
    v_mul_f32 v210, s24, v210
    v_mul_f32 v211, s24, v211
    v_mul_f32 v212, s24, v212
    v_mul_f32 v213, s24, v213
    s_mov_b32 s29, 1
    s_barrier
    s_mov_b32 s26, s42
    s_mov_b32 s27, s42
    s_mov_b32 s14, 524288
    s_mov_b32 s18, 524288
    s_add_u32 m0, s25, 0
    s_nop 0
    buffer_load_dwordx4 v228, s[12:15], s26 offen offset:0 nt lds
    buffer_load_dwordx4 v229, s[12:15], s26 offen offset:1024 nt lds
    buffer_load_dwordx4 v230, s[12:15], s26 offen offset:2048 nt lds
    buffer_load_dwordx4 v231, s[12:15], s26 offen offset:3072 nt lds
    s_add_u32 s26, s26, 16384
    s_and_b32 s26, s26, 0x7ffff
    v_mov_b32 v0, 0
    v_mov_b32 v1, 0
    v_mov_b32 v2, 0
    v_mov_b32 v3, 0
    v_mov_b32 v4, 0
    v_mov_b32 v5, 0
    v_mov_b32 v6, 0
    v_mov_b32 v7, 0
    v_mov_b32 v8, 0
    v_mov_b32 v9, 0
    v_mov_b32 v10, 0
    v_mov_b32 v11, 0
    v_mov_b32 v12, 0
    v_mov_b32 v13, 0
    v_mov_b32 v14, 0
    v_mov_b32 v15, 0
    v_mov_b32 v16, 0
    v_mov_b32 v17, 0
    v_mov_b32 v18, 0
    v_mov_b32 v19, 0
    v_mov_b32 v20, 0
    v_mov_b32 v21, 0
    v_mov_b32 v22, 0
    v_mov_b32 v23, 0
    v_mov_b32 v24, 0
    v_mov_b32 v25, 0
    v_mov_b32 v26, 0
    v_mov_b32 v27, 0
    v_mov_b32 v28, 0
    v_mov_b32 v29, 0
    v_mov_b32 v30, 0
    v_mov_b32 v31, 0
    v_mov_b32 v32, 0
    v_mov_b32 v33, 0
    v_mov_b32 v34, 0
    v_mov_b32 v35, 0
    v_mov_b32 v36, 0
    v_mov_b32 v37, 0
    v_mov_b32 v38, 0
    v_mov_b32 v39, 0
    v_mov_b32 v40, 0
    v_mov_b32 v41, 0
    v_mov_b32 v42, 0
    v_mov_b32 v43, 0
    v_mov_b32 v44, 0
    v_mov_b32 v45, 0
    v_mov_b32 v46, 0
    v_mov_b32 v47, 0
    v_mov_b32 v48, 0
    v_mov_b32 v49, 0
    v_mov_b32 v50, 0
    v_mov_b32 v51, 0
    v_mov_b32 v52, 0
    v_mov_b32 v53, 0
    v_mov_b32 v54, 0
    v_mov_b32 v55, 0
    v_mov_b32 v56, 0
    v_mov_b32 v57, 0
    v_mov_b32 v58, 0
    v_mov_b32 v59, 0
    v_mov_b32 v60, 0
    v_mov_b32 v61, 0
    v_mov_b32 v62, 0
    v_mov_b32 v63, 0
    v_mov_b32 v64, 0
    v_mov_b32 v65, 0
    v_mov_b32 v66, 0
    v_mov_b32 v67, 0
    v_mov_b32 v68, 0
    v_mov_b32 v69, 0
    v_mov_b32 v70, 0
    v_mov_b32 v71, 0
    v_mov_b32 v72, 0
    v_mov_b32 v73, 0
    v_mov_b32 v74, 0
    v_mov_b32 v75, 0
    v_mov_b32 v76, 0
    v_mov_b32 v77, 0
    v_mov_b32 v78, 0
    v_mov_b32 v79, 0
    v_mov_b32 v80, 0
    v_mov_b32 v81, 0
    v_mov_b32 v82, 0
    v_mov_b32 v83, 0
    v_mov_b32 v84, 0
    v_mov_b32 v85, 0
    v_mov_b32 v86, 0
    v_mov_b32 v87, 0
    v_mov_b32 v88, 0
    v_mov_b32 v89, 0
    v_mov_b32 v90, 0
    v_mov_b32 v91, 0
    v_mov_b32 v92, 0
    v_mov_b32 v93, 0
    v_mov_b32 v94, 0
    v_mov_b32 v95, 0
    v_mov_b32 v96, 0
    v_mov_b32 v97, 0
    v_mov_b32 v98, 0
    v_mov_b32 v99, 0
    v_mov_b32 v100, 0
    v_mov_b32 v101, 0
    v_mov_b32 v102, 0
    v_mov_b32 v103, 0
    v_mov_b32 v104, 0
    v_mov_b32 v105, 0
    v_mov_b32 v106, 0
    v_mov_b32 v107, 0
    v_mov_b32 v108, 0
    v_mov_b32 v109, 0
    v_mov_b32 v110, 0
    v_mov_b32 v111, 0
    v_mov_b32 v112, 0
    v_mov_b32 v113, 0
    v_mov_b32 v114, 0
    v_mov_b32 v115, 0
    v_mov_b32 v116, 0
    v_mov_b32 v117, 0
    v_mov_b32 v118, 0
    v_mov_b32 v119, 0
    v_mov_b32 v120, 0
    v_mov_b32 v121, 0
    v_mov_b32 v122, 0
    v_mov_b32 v123, 0
    v_mov_b32 v124, 0
    v_mov_b32 v125, 0
    v_mov_b32 v126, 0
    v_mov_b32 v127, 0
    v_mov_b32 v128, 0
    v_mov_b32 v129, 0
    v_mov_b32 v130, 0
    v_mov_b32 v131, 0
    v_mov_b32 v132, 0
    v_mov_b32 v133, 0
    v_mov_b32 v134, 0
    v_mov_b32 v135, 0
    v_mov_b32 v136, 0
    v_mov_b32 v137, 0
    v_mov_b32 v138, 0
    v_mov_b32 v139, 0
    v_mov_b32 v140, 0
    v_mov_b32 v141, 0
    v_mov_b32 v142, 0
    v_mov_b32 v143, 0
    v_mov_b32 v144, 0
    v_mov_b32 v145, 0
    v_mov_b32 v146, 0
    v_mov_b32 v147, 0
    v_mov_b32 v148, 0
    v_mov_b32 v149, 0
    v_mov_b32 v150, 0
    v_mov_b32 v151, 0
    v_mov_b32 v152, 0
    v_mov_b32 v153, 0
    v_mov_b32 v154, 0
    v_mov_b32 v155, 0
    v_mov_b32 v156, 0
    v_mov_b32 v157, 0
    v_mov_b32 v158, 0
    v_mov_b32 v159, 0
    v_mov_b32 v204, 0
    v_mov_b32 v205, 0
    v_mov_b32 v206, 0
    v_mov_b32 v207, 0
    v_mov_b32 v208, 0
    s_waitcnt vmcnt(0)
    s_barrier
    ds_read_b128 a[160:163], v214 offset:0
    ds_read_b128 a[164:167], v215 offset:0
    ds_read_b128 a[168:171], v216 offset:0
    ds_read_b128 a[172:175], v217 offset:0
    ds_read_b128 a[176:179], v214 offset:256
    ds_read_b128 a[180:183], v215 offset:256
    ds_read_b128 a[184:187], v216 offset:256
    ds_read_b128 a[188:191], v217 offset:256
    s_add_u32 m0, s25, 16384
    s_nop 0
    buffer_load_dwordx4 v228, s[12:15], s26 offen offset:0 nt lds
    buffer_load_dwordx4 v229, s[12:15], s26 offen offset:1024 nt lds
    buffer_load_dwordx4 v230, s[12:15], s26 offen offset:2048 nt lds
    buffer_load_dwordx4 v231, s[12:15], s26 offen offset:3072 nt lds
    s_add_u32 s26, s26, 16384
    s_and_b32 s26, s26, 0x7ffff
    s_add_u32 m0, s25, 65536
    s_nop 0
    buffer_load_dwordx4 v232, s[16:19], s27 offen offset:0 nt lds
    buffer_load_dwordx4 v233, s[16:19], s27 offen offset:1024 nt lds
    buffer_load_dwordx4 v234, s[16:19], s27 offen offset:2048 nt lds
    buffer_load_dwordx4 v235, s[16:19], s27 offen offset:3072 nt lds
    s_add_u32 s27, s27, 16384
    s_and_b32 s27, s27, 0x7ffff
    s_add_u32 m0, s25, 32768
    s_nop 0
    buffer_load_dwordx4 v228, s[12:15], s26 offen offset:0 nt lds
    buffer_load_dwordx4 v229, s[12:15], s26 offen offset:1024 nt lds
    buffer_load_dwordx4 v230, s[12:15], s26 offen offset:2048 nt lds
    buffer_load_dwordx4 v231, s[12:15], s26 offen offset:3072 nt lds
    s_add_u32 s26, s26, 16384
    s_and_b32 s26, s26, 0x7ffff
    s_add_u32 m0, s25, 81920
    s_nop 0
    buffer_load_dwordx4 v232, s[16:19], s27 offen offset:0 nt lds
    buffer_load_dwordx4 v233, s[16:19], s27 offen offset:1024 nt lds
    buffer_load_dwordx4 v234, s[16:19], s27 offen offset:2048 nt lds
    buffer_load_dwordx4 v235, s[16:19], s27 offen offset:3072 nt lds
    s_add_u32 s27, s27, 16384
    s_and_b32 s27, s27, 0x7ffff
    s_waitcnt lgkmcnt(0)
    v_mfma_f32_16x16x32_bf16 v[160:163], a[160:163], a[0:3], 0
    v_mfma_f32_16x16x32_bf16 v[160:163], a[164:167], a[4:7], v[160:163]
    v_mfma_f32_16x16x32_bf16 v[160:163], a[168:171], a[8:11], v[160:163]
    v_mfma_f32_16x16x32_bf16 v[160:163], a[172:175], a[12:15], v[160:163]
    v_mfma_f32_16x16x32_bf16 v[160:163], a[176:179], a[16:19], v[160:163]
    v_mfma_f32_16x16x32_bf16 v[160:163], a[180:183], a[20:23], v[160:163]
    v_mfma_f32_16x16x32_bf16 v[160:163], a[184:187], a[24:27], v[160:163]
    v_mfma_f32_16x16x32_bf16 v[160:163], a[188:191], a[28:31], v[160:163]
    v_mfma_f32_16x16x32_bf16 v[164:167], a[160:163], a[32:35], 0
    v_mfma_f32_16x16x32_bf16 v[164:167], a[164:167], a[36:39], v[164:167]
    v_mfma_f32_16x16x32_bf16 v[164:167], a[168:171], a[40:43], v[164:167]
    v_mfma_f32_16x16x32_bf16 v[164:167], a[172:175], a[44:47], v[164:167]
    v_mfma_f32_16x16x32_bf16 v[164:167], a[176:179], a[48:51], v[164:167]
    v_mfma_f32_16x16x32_bf16 v[164:167], a[180:183], a[52:55], v[164:167]
    v_mfma_f32_16x16x32_bf16 v[164:167], a[184:187], a[56:59], v[164:167]
    v_mfma_f32_16x16x32_bf16 v[164:167], a[188:191], a[60:63], v[164:167]
    v_mfma_f32_16x16x32_bf16 v[168:171], a[160:163], a[64:67], 0
    v_mfma_f32_16x16x32_bf16 v[168:171], a[164:167], a[68:71], v[168:171]
    v_mfma_f32_16x16x32_bf16 v[168:171], a[168:171], a[72:75], v[168:171]
    v_mfma_f32_16x16x32_bf16 v[168:171], a[172:175], a[76:79], v[168:171]
    v_mfma_f32_16x16x32_bf16 v[168:171], a[176:179], a[80:83], v[168:171]
    v_mfma_f32_16x16x32_bf16 v[168:171], a[180:183], a[84:87], v[168:171]
    v_mfma_f32_16x16x32_bf16 v[168:171], a[184:187], a[88:91], v[168:171]
    v_mfma_f32_16x16x32_bf16 v[168:171], a[188:191], a[92:95], v[168:171]
    v_mfma_f32_16x16x32_bf16 v[172:175], a[160:163], a[96:99], 0
    v_mfma_f32_16x16x32_bf16 v[172:175], a[164:167], a[100:103], v[172:175]
    v_mfma_f32_16x16x32_bf16 v[172:175], a[168:171], a[104:107], v[172:175]
    v_mfma_f32_16x16x32_bf16 v[172:175], a[172:175], a[108:111], v[172:175]
    v_mfma_f32_16x16x32_bf16 v[172:175], a[176:179], a[112:115], v[172:175]
    v_mfma_f32_16x16x32_bf16 v[172:175], a[180:183], a[116:119], v[172:175]
    v_mfma_f32_16x16x32_bf16 v[172:175], a[184:187], a[120:123], v[172:175]
    v_mfma_f32_16x16x32_bf16 v[172:175], a[188:191], a[124:127], v[172:175]
    v_mfma_f32_16x16x32_bf16 v[176:179], a[160:163], a[128:131], 0
    v_mfma_f32_16x16x32_bf16 v[176:179], a[164:167], a[132:135], v[176:179]
    v_mfma_f32_16x16x32_bf16 v[176:179], a[168:171], a[136:139], v[176:179]
    v_mfma_f32_16x16x32_bf16 v[176:179], a[172:175], a[140:143], v[176:179]
    v_mfma_f32_16x16x32_bf16 v[176:179], a[176:179], a[144:147], v[176:179]
    v_mfma_f32_16x16x32_bf16 v[176:179], a[180:183], a[148:151], v[176:179]
    v_mfma_f32_16x16x32_bf16 v[176:179], a[184:187], a[152:155], v[176:179]
    v_mfma_f32_16x16x32_bf16 v[176:179], a[188:191], a[156:159], v[176:179]
    s_nop 7
    s_waitcnt vmcnt(12) lgkmcnt(0)
    s_barrier
    ds_read_b128 a[160:163], v214 offset:16384
    ds_read_b128 a[164:167], v215 offset:16384
    ds_read_b128 a[168:171], v216 offset:16384
    ds_read_b128 a[172:175], v217 offset:16384
    ds_read_b128 a[176:179], v214 offset:16640
    ds_read_b128 a[180:183], v215 offset:16640
    ds_read_b128 a[184:187], v216 offset:16640
    ds_read_b128 a[188:191], v217 offset:16640
    v_fma_f32 v160, v160, s24, -v209
    v_fma_f32 v161, v161, s24, -v209
    v_fma_f32 v162, v162, s24, -v209
    v_fma_f32 v163, v163, s24, -v209
    v_exp_f32 v160, v160
    v_exp_f32 v161, v161
    v_exp_f32 v162, v162
    v_exp_f32 v163, v163
    s_nop 0
    v_cvt_pk_bf16_f32 v200, v160, v161
    v_cvt_pk_bf16_f32 v201, v162, v163
    v_add_f32 v204, v204, v160
    v_add_f32 v204, v204, v161
    v_add_f32 v204, v204, v162
    v_add_f32 v204, v204, v163
    ds_write_b64 v226, v[200:201] offset:0
    v_fma_f32 v164, v164, s24, -v210
    v_fma_f32 v165, v165, s24, -v210
    v_fma_f32 v166, v166, s24, -v210
    v_fma_f32 v167, v167, s24, -v210
    v_exp_f32 v164, v164
    v_exp_f32 v165, v165
    v_exp_f32 v166, v166
    v_exp_f32 v167, v167
    s_nop 0
    v_cvt_pk_bf16_f32 v202, v164, v165
    v_cvt_pk_bf16_f32 v203, v166, v167
    v_add_f32 v205, v205, v164
    v_add_f32 v205, v205, v165
    v_add_f32 v205, v205, v166
    v_add_f32 v205, v205, v167
    ds_write_b64 v226, v[202:203] offset:1024
    v_fma_f32 v168, v168, s24, -v211
    v_fma_f32 v169, v169, s24, -v211
    v_fma_f32 v170, v170, s24, -v211
    v_fma_f32 v171, v171, s24, -v211
    v_exp_f32 v168, v168
    v_exp_f32 v169, v169
    v_exp_f32 v170, v170
    v_exp_f32 v171, v171
    s_nop 0
    v_cvt_pk_bf16_f32 v200, v168, v169
    v_cvt_pk_bf16_f32 v201, v170, v171
    v_add_f32 v206, v206, v168
    v_add_f32 v206, v206, v169
    v_add_f32 v206, v206, v170
    v_add_f32 v206, v206, v171
    ds_write_b64 v226, v[200:201] offset:2048
    v_fma_f32 v172, v172, s24, -v212
    v_fma_f32 v173, v173, s24, -v212
    v_fma_f32 v174, v174, s24, -v212
    v_fma_f32 v175, v175, s24, -v212
    v_exp_f32 v172, v172
    v_exp_f32 v173, v173
    v_exp_f32 v174, v174
    v_exp_f32 v175, v175
    s_nop 0
    v_cvt_pk_bf16_f32 v202, v172, v173
    v_cvt_pk_bf16_f32 v203, v174, v175
    v_add_f32 v207, v207, v172
    v_add_f32 v207, v207, v173
    v_add_f32 v207, v207, v174
    v_add_f32 v207, v207, v175
    ds_write_b64 v226, v[202:203] offset:3072
    v_fma_f32 v176, v176, s24, -v213
    v_fma_f32 v177, v177, s24, -v213
    v_fma_f32 v178, v178, s24, -v213
    v_fma_f32 v179, v179, s24, -v213
    v_exp_f32 v176, v176
    v_exp_f32 v177, v177
    s_waitcnt lgkmcnt(0)
    s_branch L_main_n5
L_path4:
    s_mov_b32 s24, 0x3db8aa3b
    s_mov_b32 s29, 0
    s_mov_b32 s44, 0
    s_mov_b32 s45, 16384
    s_mov_b32 s46, 32768
    s_mov_b32 s47, 49152
    s_mov_b32 s48, 65536
    v_and_b32 v251, 15, v236
    v_lshrrev_b32 v252, 4, v236
    s_lshl_b32 s34, s32, 13
    v_lshlrev_b32 v253, 9, v251
    v_add_u32 v253, s34, v253
    v_add_u32 v254, 0, v252
    v_xor_b32 v254, v254, v251
    v_lshl_add_u32 v214, v254, 4, v253
    v_add_u32 v254, 4, v252
    v_xor_b32 v254, v254, v251
    v_lshl_add_u32 v215, v254, 4, v253
    v_add_u32 v254, 8, v252
    v_xor_b32 v254, v254, v251
    v_lshl_add_u32 v216, v254, 4, v253
    v_add_u32 v254, 12, v252
    v_xor_b32 v254, v254, v251
    v_lshl_add_u32 v217, v254, 4, v253
    v_lshrrev_b32 v6, 5, v236
    v_and_b32 v7, 31, v236
    s_lshl_b32 s34, s30, 3
    v_add_u32 v3, s34, v6
    v_lshlrev_b32 v8, 9, v3
    v_add_u32 v4, 0, v6
    v_lshlrev_b32 v4, 1, v4
    v_xor_b32 v4, v4, v7
    v_lshl_add_u32 v232, v4, 4, v8
    v_add_u32 v4, 2, v6
    v_lshlrev_b32 v4, 1, v4
    v_xor_b32 v4, v4, v7
    v_lshl_add_u32 v233, v4, 4, v8
    v_add_u32 v4, 4, v6
    v_lshlrev_b32 v4, 1, v4
    v_xor_b32 v4, v4, v7
    v_lshl_add_u32 v234, v4, 4, v8
    v_add_u32 v4, 6, v6
    v_lshlrev_b32 v4, 1, v4
    v_xor_b32 v4, v4, v7
    v_lshl_add_u32 v235, v4, 4, v8
    v_and_b32 v1, 15, v236
    v_lshrrev_b32 v2, 4, v236
    s_sub_u32 s34, s31, s32
    s_lshl_b32 s34, s34, 13
    v_add_u32 v238, s34, v214
    v_add_u32 v239, s34, v215
    v_add_u32 v240, s34, v216
    v_add_u32 v241, s34, v217
    s_mul_i32 s34, s33, 160
    s_lshl_b32 s35, s31, 4
    s_add_u32 s34, s34, s35
    v_add_u32 v3, s34, v2
    v_lshlrev_b32 v3, 9, v3
    v_lshl_add_u32 v3, v1, 4, v3
    s_lshl_b32 s35, s32, 8
    v_add_u32 v249, s35, v3
    v_add_u32 v250, 4096, v249
    v_lshrrev_b32 v6, 2, v1
    v_and_b32 v7, 3, v1
    v_and_b32 v8, 1, v2
    v_lshlrev_b32 v8, 2, v8
    v_add_u32 v8, v8, v6
    v_lshlrev_b32 v3, 2, v2
    v_add_u32 v3, v3, v6
    v_lshlrev_b32 v3, 9, v3
    v_lshrrev_b32 v4, 1, v7
    v_lshlrev_b32 v4, 4, v4
    v_and_b32 v5, 1, v7
    v_lshlrev_b32 v5, 3, v5
    v_add3_u32 v3, v3, v4, v5
    s_lshl_b32 s34, s32, 8
    s_add_u32 s34, s34, 65536
    v_add_u32 v3, s34, v3
    v_xor_b32 v4, 0, v8
    v_lshl_add_u32 v218, v4, 5, v3
    v_xor_b32 v4, 1, v8
    v_lshl_add_u32 v219, v4, 5, v3
    v_xor_b32 v4, 2, v8
    v_lshl_add_u32 v220, v4, 5, v3
    v_xor_b32 v4, 3, v8
    v_lshl_add_u32 v221, v4, 5, v3
    v_xor_b32 v4, 4, v8
    v_lshl_add_u32 v222, v4, 5, v3
    v_xor_b32 v4, 5, v8
    v_lshl_add_u32 v223, v4, 5, v3
    v_xor_b32 v4, 6, v8
    v_lshl_add_u32 v224, v4, 5, v3
    v_xor_b32 v4, 7, v8
    v_lshl_add_u32 v225, v4, 5, v3
    s_mul_i32 s34, s31, 5120
    s_add_u32 s34, s34, 131072
    v_lshlrev_b32 v3, 4, v236
    v_add_u32 v227, s34, v3
    s_lshl_b32 s35, s32, 3
    v_add_u32 v226, s35, v227
    v_lshlrev_b32 v3, 2, v236
    s_mul_i32 s34, s30, 1280
    s_add_u32 s34, s34, 151552
    v_add_u32 v237, s34, v3
    s_xor_b32 s35, s30, 1
    s_mul_i32 s34, s35, 1280
    s_add_u32 s34, s34, 151552
    v_add_u32 v248, s34, v3
    v_subrev_u32 v246, 151552, v237
    v_subrev_u32 v247, 151552, v248
    v_mov_b32 v0, 0
    v_mov_b32 v1, 0
    v_mov_b32 v2, 0
    v_mov_b32 v3, 0
    v_mov_b32 v4, 0
    v_mov_b32 v5, 0
    v_mov_b32 v6, 0
    v_mov_b32 v7, 0
    v_mov_b32 v8, 0
    v_mov_b32 v9, 0
    v_mov_b32 v10, 0
    v_mov_b32 v11, 0
    v_mov_b32 v12, 0
    v_mov_b32 v13, 0
    v_mov_b32 v14, 0
    v_mov_b32 v15, 0
    v_mov_b32 v16, 0
    v_mov_b32 v17, 0
    v_mov_b32 v18, 0
    v_mov_b32 v19, 0
    v_mov_b32 v20, 0
    v_mov_b32 v21, 0
    v_mov_b32 v22, 0
    v_mov_b32 v23, 0
    v_mov_b32 v24, 0
    v_mov_b32 v25, 0
    v_mov_b32 v26, 0
    v_mov_b32 v27, 0
    v_mov_b32 v28, 0
    v_mov_b32 v29, 0
    v_mov_b32 v30, 0
    v_mov_b32 v31, 0
    v_mov_b32 v32, 0
    v_mov_b32 v33, 0
    v_mov_b32 v34, 0
    v_mov_b32 v35, 0
    v_mov_b32 v36, 0
    v_mov_b32 v37, 0
    v_mov_b32 v38, 0
    v_mov_b32 v39, 0
    v_mov_b32 v40, 0
    v_mov_b32 v41, 0
    v_mov_b32 v42, 0
    v_mov_b32 v43, 0
    v_mov_b32 v44, 0
    v_mov_b32 v45, 0
    v_mov_b32 v46, 0
    v_mov_b32 v47, 0
    v_mov_b32 v48, 0
    v_mov_b32 v49, 0
    v_mov_b32 v50, 0
    v_mov_b32 v51, 0
    v_mov_b32 v52, 0
    v_mov_b32 v53, 0
    v_mov_b32 v54, 0
    v_mov_b32 v55, 0
    v_mov_b32 v56, 0
    v_mov_b32 v57, 0
    v_mov_b32 v58, 0
    v_mov_b32 v59, 0
    v_mov_b32 v60, 0
    v_mov_b32 v61, 0
    v_mov_b32 v62, 0
    v_mov_b32 v63, 0
    v_mov_b32 v64, 0
    v_mov_b32 v65, 0
    v_mov_b32 v66, 0
    v_mov_b32 v67, 0
    v_mov_b32 v68, 0
    v_mov_b32 v69, 0
    v_mov_b32 v70, 0
    v_mov_b32 v71, 0
    v_mov_b32 v72, 0
    v_mov_b32 v73, 0
    v_mov_b32 v74, 0
    v_mov_b32 v75, 0
    v_mov_b32 v76, 0
    v_mov_b32 v77, 0
    v_mov_b32 v78, 0
    v_mov_b32 v79, 0
    v_mov_b32 v80, 0
    v_mov_b32 v81, 0
    v_mov_b32 v82, 0
    v_mov_b32 v83, 0
    v_mov_b32 v84, 0
    v_mov_b32 v85, 0
    v_mov_b32 v86, 0
    v_mov_b32 v87, 0
    v_mov_b32 v88, 0
    v_mov_b32 v89, 0
    v_mov_b32 v90, 0
    v_mov_b32 v91, 0
    v_mov_b32 v92, 0
    v_mov_b32 v93, 0
    v_mov_b32 v94, 0
    v_mov_b32 v95, 0
    v_mov_b32 v96, 0
    v_mov_b32 v97, 0
    v_mov_b32 v98, 0
    v_mov_b32 v99, 0
    v_mov_b32 v100, 0
    v_mov_b32 v101, 0
    v_mov_b32 v102, 0
    v_mov_b32 v103, 0
    v_mov_b32 v104, 0
    v_mov_b32 v105, 0
    v_mov_b32 v106, 0
    v_mov_b32 v107, 0
    v_mov_b32 v108, 0
    v_mov_b32 v109, 0
    v_mov_b32 v110, 0
    v_mov_b32 v111, 0
    v_mov_b32 v112, 0
    v_mov_b32 v113, 0
    v_mov_b32 v114, 0
    v_mov_b32 v115, 0
    v_mov_b32 v116, 0
    v_mov_b32 v117, 0
    v_mov_b32 v118, 0
    v_mov_b32 v119, 0
    v_mov_b32 v120, 0
    v_mov_b32 v121, 0
    v_mov_b32 v122, 0
    v_mov_b32 v123, 0
    v_mov_b32 v124, 0
    v_mov_b32 v125, 0
    v_mov_b32 v126, 0
    v_mov_b32 v127, 0
    v_mov_b32 v204, 0
    v_mov_b32 v205, 0
    v_mov_b32 v206, 0
    v_mov_b32 v207, 0
    s_waitcnt vmcnt(16)
    s_barrier
    ds_read_b128 a[160:163], v214 offset:0
    ds_read_b128 a[164:167], v215 offset:0
    ds_read_b128 a[168:171], v216 offset:0
    ds_read_b128 a[172:175], v217 offset:0
    ds_read_b128 a[176:179], v214 offset:256
    ds_read_b128 a[180:183], v215 offset:256
    ds_read_b128 a[184:187], v216 offset:256
    ds_read_b128 a[188:191], v217 offset:256
    v_add_u32 v242, 131072, v238
    v_add_u32 v243, 131072, v239
    v_add_u32 v244, 131072, v240
    v_add_u32 v245, 131072, v241
    ds_read_b128 a[0:3], v242 offset:0
    ds_read_b128 a[4:7], v243 offset:0
    ds_read_b128 a[8:11], v244 offset:0
    ds_read_b128 a[12:15], v245 offset:0
    ds_read_b128 a[16:19], v242 offset:256
    ds_read_b128 a[20:23], v243 offset:256
    ds_read_b128 a[24:27], v244 offset:256
    ds_read_b128 a[28:31], v245 offset:256
    s_add_u32 m0, s25, 16384
    s_nop 0
    buffer_load_dwordx4 v228, s[12:15], s26 offen offset:0 nt lds
    buffer_load_dwordx4 v229, s[12:15], s26 offen offset:1024 nt lds
    buffer_load_dwordx4 v230, s[12:15], s26 offen offset:2048 nt lds
    buffer_load_dwordx4 v231, s[12:15], s26 offen offset:3072 nt lds
    s_add_u32 s26, s26, 16384
    s_and_b32 s26, s26, 0x7ffff
    s_waitcnt lgkmcnt(0)
    v_mfma_f32_16x16x32_bf16 v[160:163], a[160:163], a[0:3], 0
    v_mfma_f32_16x16x32_bf16 v[160:163], a[164:167], a[4:7], v[160:163]
    v_mfma_f32_16x16x32_bf16 v[160:163], a[168:171], a[8:11], v[160:163]
    v_mfma_f32_16x16x32_bf16 v[160:163], a[172:175], a[12:15], v[160:163]
    v_mfma_f32_16x16x32_bf16 v[160:163], a[176:179], a[16:19], v[160:163]
    v_mfma_f32_16x16x32_bf16 v[160:163], a[180:183], a[20:23], v[160:163]
    v_mfma_f32_16x16x32_bf16 v[160:163], a[184:187], a[24:27], v[160:163]
    v_mfma_f32_16x16x32_bf16 v[160:163], a[188:191], a[28:31], v[160:163]
    s_nop 7
    v_max3_f32 v209, v160, v161, v162
    v_max_f32 v209, v209, v163
    v_mov_b32 v251, v209
    s_nop 1
    v_permlane32_swap_b32 v251, v209
    v_max_f32 v209, v209, v251
    v_mov_b32 v251, v209
    s_nop 1
    v_permlane16_swap_b32 v251, v209
    v_max_f32 v209, v209, v251
    s_waitcnt vmcnt(16) lgkmcnt(0)
    s_barrier
    ds_write_b32 v246, v209 offset:0
    v_add_u32 v242, 147456, v238
    v_add_u32 v243, 147456, v239
    v_add_u32 v244, 147456, v240
    v_add_u32 v245, 147456, v241
    ds_read_b128 a[32:35], v242 offset:0
    ds_read_b128 a[36:39], v243 offset:0
    ds_read_b128 a[40:43], v244 offset:0
    ds_read_b128 a[44:47], v245 offset:0
    ds_read_b128 a[48:51], v242 offset:256
    ds_read_b128 a[52:55], v243 offset:256
    ds_read_b128 a[56:59], v244 offset:256
    ds_read_b128 a[60:63], v245 offset:256
    s_add_u32 m0, s25, 65536
    s_nop 0
    buffer_load_dwordx4 v232, s[16:19], s27 offen offset:0 nt lds
    buffer_load_dwordx4 v233, s[16:19], s27 offen offset:1024 nt lds
    buffer_load_dwordx4 v234, s[16:19], s27 offen offset:2048 nt lds
    buffer_load_dwordx4 v235, s[16:19], s27 offen offset:3072 nt lds
    s_add_u32 s27, s27, 16384
    s_and_b32 s27, s27, 0x7ffff
    s_waitcnt lgkmcnt(0)
    v_mfma_f32_16x16x32_bf16 v[164:167], a[160:163], a[32:35], 0
    v_mfma_f32_16x16x32_bf16 v[164:167], a[164:167], a[36:39], v[164:167]
    v_mfma_f32_16x16x32_bf16 v[164:167], a[168:171], a[40:43], v[164:167]
    v_mfma_f32_16x16x32_bf16 v[164:167], a[172:175], a[44:47], v[164:167]
    v_mfma_f32_16x16x32_bf16 v[164:167], a[176:179], a[48:51], v[164:167]
    v_mfma_f32_16x16x32_bf16 v[164:167], a[180:183], a[52:55], v[164:167]
    v_mfma_f32_16x16x32_bf16 v[164:167], a[184:187], a[56:59], v[164:167]
    v_mfma_f32_16x16x32_bf16 v[164:167], a[188:191], a[60:63], v[164:167]
    s_nop 7
    v_max3_f32 v210, v164, v165, v166
    v_max_f32 v210, v210, v167
    v_mov_b32 v251, v210
    s_nop 1
    v_permlane32_swap_b32 v251, v210
    v_max_f32 v210, v210, v251
    v_mov_b32 v251, v210
    s_nop 1
    v_permlane16_swap_b32 v251, v210
    v_max_f32 v210, v210, v251
    s_waitcnt vmcnt(16) lgkmcnt(0)
    s_barrier
    ds_read_b32 v252, v247 offset:0
    ds_write_b32 v246, v210 offset:256
    v_add_u32 v242, 49152, v238
    v_add_u32 v243, 49152, v239
    v_add_u32 v244, 49152, v240
    v_add_u32 v245, 49152, v241
    ds_read_b128 a[64:67], v242 offset:0
    ds_read_b128 a[68:71], v243 offset:0
    ds_read_b128 a[72:75], v244 offset:0
    ds_read_b128 a[76:79], v245 offset:0
    ds_read_b128 a[80:83], v242 offset:256
    ds_read_b128 a[84:87], v243 offset:256
    ds_read_b128 a[88:91], v244 offset:256
    ds_read_b128 a[92:95], v245 offset:256
    s_add_u32 m0, s25, 32768
    s_nop 0
    buffer_load_dwordx4 v228, s[12:15], s26 offen offset:0 nt lds
    buffer_load_dwordx4 v229, s[12:15], s26 offen offset:1024 nt lds
    buffer_load_dwordx4 v230, s[12:15], s26 offen offset:2048 nt lds
    buffer_load_dwordx4 v231, s[12:15], s26 offen offset:3072 nt lds
    s_add_u32 s26, s26, 16384
    s_and_b32 s26, s26, 0x7ffff
    s_waitcnt lgkmcnt(9)
    v_max_f32 v209, v209, v252
    v_mul_f32 v209, s24, v209
    v_fma_f32 v160, v160, s24, -v209
    v_fma_f32 v161, v161, s24, -v209
    v_fma_f32 v162, v162, s24, -v209
    v_fma_f32 v163, v163, s24, -v209
    v_exp_f32 v160, v160
    v_exp_f32 v161, v161
    v_exp_f32 v162, v162
    v_exp_f32 v163, v163
    s_nop 0
    v_cvt_pk_bf16_f32 v200, v160, v161
    v_cvt_pk_bf16_f32 v201, v162, v163
    v_add_f32 v204, v204, v160
    v_add_f32 v204, v204, v161
    v_add_f32 v204, v204, v162
    v_add_f32 v204, v204, v163
    ds_write_b64 v226, v[200:201] offset:0
    s_waitcnt lgkmcnt(1)
    v_mfma_f32_16x16x32_bf16 v[168:171], a[160:163], a[64:67], 0
    v_mfma_f32_16x16x32_bf16 v[168:171], a[164:167], a[68:71], v[168:171]
    v_mfma_f32_16x16x32_bf16 v[168:171], a[168:171], a[72:75], v[168:171]
    v_mfma_f32_16x16x32_bf16 v[168:171], a[172:175], a[76:79], v[168:171]
    v_mfma_f32_16x16x32_bf16 v[168:171], a[176:179], a[80:83], v[168:171]
    v_mfma_f32_16x16x32_bf16 v[168:171], a[180:183], a[84:87], v[168:171]
    v_mfma_f32_16x16x32_bf16 v[168:171], a[184:187], a[88:91], v[168:171]
    v_mfma_f32_16x16x32_bf16 v[168:171], a[188:191], a[92:95], v[168:171]
    s_nop 7
    v_max3_f32 v211, v168, v169, v170
    v_max_f32 v211, v211, v171
    v_mov_b32 v251, v211
    s_nop 1
    v_permlane32_swap_b32 v251, v211
    v_max_f32 v211, v211, v251
    v_mov_b32 v251, v211
    s_nop 1
    v_permlane16_swap_b32 v251, v211
    v_max_f32 v211, v211, v251
    s_waitcnt vmcnt(16) lgkmcnt(0)
    s_barrier
    ds_read_b32 v252, v247 offset:256
    ds_write_b32 v246, v211 offset:512
    v_add_u32 v242, 98304, v238
    v_add_u32 v243, 98304, v239
    v_add_u32 v244, 98304, v240
    v_add_u32 v245, 98304, v241
    ds_read_b128 a[96:99], v242 offset:0
    ds_read_b128 a[100:103], v243 offset:0
    ds_read_b128 a[104:107], v244 offset:0
    ds_read_b128 a[108:111], v245 offset:0
    ds_read_b128 a[112:115], v242 offset:256
    ds_read_b128 a[116:119], v243 offset:256
    ds_read_b128 a[120:123], v244 offset:256
    ds_read_b128 a[124:127], v245 offset:256
    s_add_u32 m0, s25, 81920
    s_nop 0
    buffer_load_dwordx4 v232, s[16:19], s27 offen offset:0 nt lds
    buffer_load_dwordx4 v233, s[16:19], s27 offen offset:1024 nt lds
    buffer_load_dwordx4 v234, s[16:19], s27 offen offset:2048 nt lds
    buffer_load_dwordx4 v235, s[16:19], s27 offen offset:3072 nt lds
    s_add_u32 s27, s27, 16384
    s_and_b32 s27, s27, 0x7ffff
    s_waitcnt lgkmcnt(9)
    v_max_f32 v210, v210, v252
    v_mul_f32 v210, s24, v210
    v_fma_f32 v164, v164, s24, -v210
    v_fma_f32 v165, v165, s24, -v210
    v_fma_f32 v166, v166, s24, -v210
    v_fma_f32 v167, v167, s24, -v210
    v_exp_f32 v164, v164
    v_exp_f32 v165, v165
    v_exp_f32 v166, v166
    v_exp_f32 v167, v167
    s_nop 0
    v_cvt_pk_bf16_f32 v202, v164, v165
    v_cvt_pk_bf16_f32 v203, v166, v167
    v_add_f32 v205, v205, v164
    v_add_f32 v205, v205, v165
    v_add_f32 v205, v205, v166
    v_add_f32 v205, v205, v167
    ds_write_b64 v226, v[202:203] offset:1024
    s_waitcnt lgkmcnt(1)
    v_mfma_f32_16x16x32_bf16 v[172:175], a[160:163], a[96:99], 0
    v_mfma_f32_16x16x32_bf16 v[172:175], a[164:167], a[100:103], v[172:175]
    v_mfma_f32_16x16x32_bf16 v[172:175], a[168:171], a[104:107], v[172:175]
    v_mfma_f32_16x16x32_bf16 v[172:175], a[172:175], a[108:111], v[172:175]
    v_mfma_f32_16x16x32_bf16 v[172:175], a[176:179], a[112:115], v[172:175]
    v_mfma_f32_16x16x32_bf16 v[172:175], a[180:183], a[116:119], v[172:175]
    v_mfma_f32_16x16x32_bf16 v[172:175], a[184:187], a[120:123], v[172:175]
    v_mfma_f32_16x16x32_bf16 v[172:175], a[188:191], a[124:127], v[172:175]
    s_nop 7
    v_max3_f32 v212, v172, v173, v174
    v_max_f32 v212, v212, v175
    v_mov_b32 v251, v212
    s_nop 1
    v_permlane32_swap_b32 v251, v212
    v_max_f32 v212, v212, v251
    v_mov_b32 v251, v212
    s_nop 1
    v_permlane16_swap_b32 v251, v212
    v_max_f32 v212, v212, v251
    s_waitcnt vmcnt(16) lgkmcnt(0)
    s_barrier
    ds_read_b32 v252, v247 offset:512
    s_waitcnt lgkmcnt(0)
    v_max_f32 v211, v211, v252
    v_mul_f32 v211, s24, v211
    v_fma_f32 v168, v168, s24, -v211
    v_fma_f32 v169, v169, s24, -v211
    v_fma_f32 v170, v170, s24, -v211
    v_fma_f32 v171, v171, s24, -v211
    v_exp_f32 v168, v168
    v_exp_f32 v169, v169
    v_exp_f32 v170, v170
    v_exp_f32 v171, v171
    s_nop 0
    v_cvt_pk_bf16_f32 v200, v168, v169
    v_cvt_pk_bf16_f32 v201, v170, v171
    v_add_f32 v206, v206, v168
    v_add_f32 v206, v206, v169
    v_add_f32 v206, v206, v170
    v_add_f32 v206, v206, v171
    ds_write_b64 v226, v[200:201] offset:2048
    ds_write_b32 v237, v212 offset:768
    s_waitcnt vmcnt(12) lgkmcnt(0)
    s_barrier
    ds_read_b32 v252, v248 offset:768
    ds_read_b128 a[160:163], v214 offset:16384
    ds_read_b128 a[164:167], v215 offset:16384
    ds_read_b128 a[168:171], v216 offset:16384
    ds_read_b128 a[172:175], v217 offset:16384
    ds_read_b128 a[176:179], v214 offset:16640
    ds_read_b128 a[180:183], v215 offset:16640
    ds_read_b128 a[184:187], v216 offset:16640
    ds_read_b128 a[188:191], v217 offset:16640
    s_waitcnt lgkmcnt(8)
    v_max_f32 v212, v212, v252
    v_mul_f32 v212, s24, v212
    v_fma_f32 v172, v172, s24, -v212
    v_fma_f32 v173, v173, s24, -v212
    v_fma_f32 v174, v174, s24, -v212
    v_fma_f32 v175, v175, s24, -v212
    v_exp_f32 v172, v172
    v_exp_f32 v173, v173
    s_waitcnt lgkmcnt(0)
L_main_n4:
    v_mfma_f32_16x16x32_bf16 v[160:163], a[160:163], a[0:3], 0
    v_exp_f32 v174, v174
    v_mfma_f32_16x16x32_bf16 v[160:163], a[164:167], a[4:7], v[160:163]
    v_cvt_pk_bf16_f32 v202, v172, v173
    v_mfma_f32_16x16x32_bf16 v[160:163], a[168:171], a[8:11], v[160:163]
    v_exp_f32 v175, v175
    v_mfma_f32_16x16x32_bf16 v[160:163], a[172:175], a[12:15], v[160:163]
    v_mfma_f32_16x16x32_bf16 v[160:163], a[176:179], a[16:19], v[160:163]
    v_cvt_pk_bf16_f32 v203, v174, v175
    v_mfma_f32_16x16x32_bf16 v[160:163], a[180:183], a[20:23], v[160:163]
    ds_write_b64 v226, v[202:203] offset:3072
    v_add_f32 v207, v207, v172
    v_mfma_f32_16x16x32_bf16 v[160:163], a[184:187], a[24:27], v[160:163]
    v_add_f32 v207, v207, v173
    v_mfma_f32_16x16x32_bf16 v[160:163], a[188:191], a[28:31], v[160:163]
    v_add_f32 v207, v207, v174
    v_mfma_f32_16x16x32_bf16 v[164:167], a[160:163], a[32:35], 0
    s_waitcnt vmcnt(8)
    v_add_f32 v207, v207, v175
    v_mfma_f32_16x16x32_bf16 v[164:167], a[164:167], a[36:39], v[164:167]
    s_barrier
    v_mfma_f32_16x16x32_bf16 v[164:167], a[168:171], a[40:43], v[164:167]
    s_add_u32 m0, s25, 49152
    ds_read_b64_tr_b16 a[192:193], v218 offset:0
    ds_read_b64_tr_b16 a[194:195], v218 offset:8192
    v_fma_f32 v160, v160, s24, -v209
    v_mfma_f32_16x16x32_bf16 v[164:167], a[172:175], a[44:47], v[164:167]
    buffer_load_dwordx4 v228, s[12:15], s26 offen offset:0 nt lds
    ds_read_b64_tr_b16 a[196:197], v219 offset:0
    v_fma_f32 v161, v161, s24, -v209
    v_mfma_f32_16x16x32_bf16 v[164:167], a[176:179], a[48:51], v[164:167]
    v_exp_f32 v160, v160
    v_mfma_f32_16x16x32_bf16 v[164:167], a[180:183], a[52:55], v[164:167]
    ds_read_b64_tr_b16 a[198:199], v219 offset:8192
    ds_read_b128 v[180:183], v227 offset:0
    v_fma_f32 v162, v162, s24, -v209
    v_mfma_f32_16x16x32_bf16 v[164:167], a[184:187], a[56:59], v[164:167]
    v_exp_f32 v161, v161
    v_mfma_f32_16x16x32_bf16 v[164:167], a[188:191], a[60:63], v[164:167]
    buffer_load_dwordx4 v229, s[12:15], s26 offen offset:1024 nt lds
    ds_read_b64_tr_b16 a[200:201], v220 offset:0
    v_fma_f32 v163, v163, s24, -v209
    v_mfma_f32_16x16x32_bf16 v[168:171], a[160:163], a[64:67], 0
    v_exp_f32 v162, v162
    v_mfma_f32_16x16x32_bf16 v[168:171], a[164:167], a[68:71], v[168:171]
    ds_read_b64_tr_b16 a[202:203], v220 offset:8192
    ds_read_b64_tr_b16 a[204:205], v221 offset:0
    v_cvt_pk_bf16_f32 v200, v160, v161
    v_mfma_f32_16x16x32_bf16 v[168:171], a[168:171], a[72:75], v[168:171]
    v_exp_f32 v163, v163
    v_mfma_f32_16x16x32_bf16 v[168:171], a[172:175], a[76:79], v[168:171]
    buffer_load_dwordx4 v230, s[12:15], s26 offen offset:2048 nt lds
    ds_read_b64_tr_b16 a[206:207], v221 offset:8192
    v_mfma_f32_16x16x32_bf16 v[168:171], a[176:179], a[80:83], v[168:171]
    ds_read_b64_tr_b16 a[208:209], v222 offset:0
    ds_read_b64_tr_b16 a[210:211], v222 offset:8192
    v_cvt_pk_bf16_f32 v201, v162, v163
    v_mfma_f32_16x16x32_bf16 v[168:171], a[180:183], a[84:87], v[168:171]
    ds_write_b64 v226, v[200:201] offset:10240
    ds_read_b64_tr_b16 a[212:213], v223 offset:0
    v_add_f32 v204, v204, v160
    v_mfma_f32_16x16x32_bf16 v[168:171], a[184:187], a[88:91], v[168:171]
    buffer_load_dwordx4 v231, s[12:15], s26 offen offset:3072 nt lds
    ds_read_b64_tr_b16 a[214:215], v223 offset:8192
    v_add_f32 v204, v204, v161
    v_mfma_f32_16x16x32_bf16 v[168:171], a[188:191], a[92:95], v[168:171]
    s_add_u32 s26, s26, 16384
    s_and_b32 s26, s26, 0x7ffff
    ds_read_b64_tr_b16 a[216:217], v224 offset:0
    ds_read_b64_tr_b16 a[218:219], v224 offset:8192
    v_add_f32 v204, v204, v162
    v_mfma_f32_16x16x32_bf16 v[172:175], a[160:163], a[96:99], 0
    ds_read_b64_tr_b16 a[220:221], v225 offset:0
    ds_read_b64_tr_b16 a[222:223], v225 offset:8192
    v_add_f32 v204, v204, v163
    v_mfma_f32_16x16x32_bf16 v[172:175], a[164:167], a[100:103], v[172:175]
    s_add_u32 m0, s25, 98304
    v_mfma_f32_16x16x32_bf16 v[172:175], a[168:171], a[104:107], v[172:175]
    buffer_load_dwordx4 v232, s[16:19], s27 offen offset:0 nt lds
    ds_read_b128 v[184:187], v227 offset:1024
    v_fma_f32 v164, v164, s24, -v210
    v_mfma_f32_16x16x32_bf16 v[172:175], a[172:175], a[108:111], v[172:175]
    v_fma_f32 v165, v165, s24, -v210
    v_mfma_f32_16x16x32_bf16 v[172:175], a[176:179], a[112:115], v[172:175]
    v_exp_f32 v164, v164
    v_mfma_f32_16x16x32_bf16 v[172:175], a[180:183], a[116:119], v[172:175]
    v_fma_f32 v166, v166, s24, -v210
    v_mfma_f32_16x16x32_bf16 v[172:175], a[184:187], a[120:123], v[172:175]
    v_exp_f32 v165, v165
    v_mfma_f32_16x16x32_bf16 v[172:175], a[188:191], a[124:127], v[172:175]
    s_waitcnt lgkmcnt(1)
    buffer_load_dwordx4 v233, s[16:19], s27 offen offset:1024 nt lds
    v_fma_f32 v167, v167, s24, -v210
    v_mfma_f32_16x16x32_bf16 v[0:3], a[192:195], v[180:183], v[0:3]
    v_exp_f32 v166, v166
    v_mfma_f32_16x16x32_bf16 v[4:7], a[196:199], v[180:183], v[4:7]
    v_cvt_pk_bf16_f32 v202, v164, v165
    v_mfma_f32_16x16x32_bf16 v[8:11], a[200:203], v[180:183], v[8:11]
    v_exp_f32 v167, v167
    v_mfma_f32_16x16x32_bf16 v[12:15], a[204:207], v[180:183], v[12:15]
    buffer_load_dwordx4 v234, s[16:19], s27 offen offset:2048 nt lds
    ds_read_b128 v[188:191], v227 offset:2048
    v_mfma_f32_16x16x32_bf16 v[16:19], a[208:211], v[180:183], v[16:19]
    v_cvt_pk_bf16_f32 v203, v166, v167
    v_mfma_f32_16x16x32_bf16 v[20:23], a[212:215], v[180:183], v[20:23]
    ds_write_b64 v226, v[202:203] offset:11264
    v_add_f32 v205, v205, v164
    v_mfma_f32_16x16x32_bf16 v[24:27], a[216:219], v[180:183], v[24:27]
    s_waitcnt vmcnt(11)
    buffer_load_dwordx4 v235, s[16:19], s27 offen offset:3072 nt lds
    v_add_f32 v205, v205, v165
    v_mfma_f32_16x16x32_bf16 v[28:31], a[220:223], v[180:183], v[28:31]
    s_barrier
    s_waitcnt lgkmcnt(2)
    s_add_u32 s27, s27, 16384
    s_and_b32 s27, s27, 0x7ffff
    v_add_f32 v205, v205, v166
    v_mfma_f32_16x16x32_bf16 v[32:35], a[192:195], v[184:187], v[32:35]
    ds_read_b128 a[160:163], v214 offset:32768
    ds_read_b128 a[164:167], v215 offset:32768
    v_add_f32 v205, v205, v167
    v_mfma_f32_16x16x32_bf16 v[36:39], a[196:199], v[184:187], v[36:39]
    s_add_u32 m0, s25, 0
    ds_read_b128 a[168:171], v216 offset:32768
    ds_read_b128 a[172:175], v217 offset:32768
    v_mfma_f32_16x16x32_bf16 v[40:43], a[200:203], v[184:187], v[40:43]
    buffer_load_dwordx4 v228, s[12:15], s26 offen offset:0 nt lds
    ds_read_b128 v[192:195], v227 offset:3072
    v_fma_f32 v168, v168, s24, -v211
    v_mfma_f32_16x16x32_bf16 v[44:47], a[204:207], v[184:187], v[44:47]
    ds_read_b128 a[176:179], v214 offset:33024
    ds_read_b128 a[180:183], v215 offset:33024
    v_fma_f32 v169, v169, s24, -v211
    v_mfma_f32_16x16x32_bf16 v[48:51], a[208:211], v[184:187], v[48:51]
    v_exp_f32 v168, v168
    v_mfma_f32_16x16x32_bf16 v[52:55], a[212:215], v[184:187], v[52:55]
    ds_read_b128 a[184:187], v216 offset:33024
    ds_read_b128 a[188:191], v217 offset:33024
    v_fma_f32 v170, v170, s24, -v211
    v_mfma_f32_16x16x32_bf16 v[56:59], a[216:219], v[184:187], v[56:59]
    v_exp_f32 v169, v169
    v_mfma_f32_16x16x32_bf16 v[60:63], a[220:223], v[184:187], v[60:63]
    s_waitcnt lgkmcnt(7)
    buffer_load_dwordx4 v229, s[12:15], s26 offen offset:1024 nt lds
    v_fma_f32 v171, v171, s24, -v211
    v_mfma_f32_16x16x32_bf16 v[64:67], a[192:195], v[188:191], v[64:67]
    v_exp_f32 v170, v170
    v_mfma_f32_16x16x32_bf16 v[68:71], a[196:199], v[188:191], v[68:71]
    v_cvt_pk_bf16_f32 v200, v168, v169
    v_mfma_f32_16x16x32_bf16 v[72:75], a[200:203], v[188:191], v[72:75]
    v_exp_f32 v171, v171
    v_mfma_f32_16x16x32_bf16 v[76:79], a[204:207], v[188:191], v[76:79]
    buffer_load_dwordx4 v230, s[12:15], s26 offen offset:2048 nt lds
    v_mfma_f32_16x16x32_bf16 v[80:83], a[208:211], v[188:191], v[80:83]
    v_cvt_pk_bf16_f32 v201, v170, v171
    v_mfma_f32_16x16x32_bf16 v[84:87], a[212:215], v[188:191], v[84:87]
    ds_write_b64 v226, v[200:201] offset:12288
    v_add_f32 v206, v206, v168
    v_mfma_f32_16x16x32_bf16 v[88:91], a[216:219], v[188:191], v[88:91]
    buffer_load_dwordx4 v231, s[12:15], s26 offen offset:3072 nt lds
    v_add_f32 v206, v206, v169
    v_mfma_f32_16x16x32_bf16 v[92:95], a[220:223], v[188:191], v[92:95]
    s_waitcnt lgkmcnt(1)
    s_add_u32 s26, s26, 16384
    s_and_b32 s26, s26, 0x7ffff
    v_add_f32 v206, v206, v170
    v_mfma_f32_16x16x32_bf16 v[96:99], a[192:195], v[192:195], v[96:99]
    v_add_f32 v206, v206, v171
    v_mfma_f32_16x16x32_bf16 v[100:103], a[196:199], v[192:195], v[100:103]
    v_mfma_f32_16x16x32_bf16 v[104:107], a[200:203], v[192:195], v[104:107]
    v_fma_f32 v172, v172, s24, -v212
    v_mfma_f32_16x16x32_bf16 v[108:111], a[204:207], v[192:195], v[108:111]
    v_fma_f32 v173, v173, s24, -v212
    v_mfma_f32_16x16x32_bf16 v[112:115], a[208:211], v[192:195], v[112:115]
    v_exp_f32 v172, v172
    v_mfma_f32_16x16x32_bf16 v[116:119], a[212:215], v[192:195], v[116:119]
    v_fma_f32 v174, v174, s24, -v212
    v_mfma_f32_16x16x32_bf16 v[120:123], a[216:219], v[192:195], v[120:123]
    v_exp_f32 v173, v173
    v_mfma_f32_16x16x32_bf16 v[124:127], a[220:223], v[192:195], v[124:127]
    v_fma_f32 v175, v175, s24, -v212
    v_mfma_f32_16x16x32_bf16 v[160:163], a[160:163], a[0:3], 0
    v_exp_f32 v174, v174
    v_mfma_f32_16x16x32_bf16 v[160:163], a[164:167], a[4:7], v[160:163]
    v_cvt_pk_bf16_f32 v202, v172, v173
    v_mfma_f32_16x16x32_bf16 v[160:163], a[168:171], a[8:11], v[160:163]
    v_exp_f32 v175, v175
    v_mfma_f32_16x16x32_bf16 v[160:163], a[172:175], a[12:15], v[160:163]
    v_mfma_f32_16x16x32_bf16 v[160:163], a[176:179], a[16:19], v[160:163]
    v_cvt_pk_bf16_f32 v203, v174, v175
    v_mfma_f32_16x16x32_bf16 v[160:163], a[180:183], a[20:23], v[160:163]
    ds_write_b64 v226, v[202:203] offset:13312
    v_add_f32 v207, v207, v172
    v_mfma_f32_16x16x32_bf16 v[160:163], a[184:187], a[24:27], v[160:163]
    v_add_f32 v207, v207, v173
    v_mfma_f32_16x16x32_bf16 v[160:163], a[188:191], a[28:31], v[160:163]
    v_add_f32 v207, v207, v174
    v_mfma_f32_16x16x32_bf16 v[164:167], a[160:163], a[32:35], 0
    s_waitcnt vmcnt(12) lgkmcnt(1)
    v_add_f32 v207, v207, v175
    v_mfma_f32_16x16x32_bf16 v[164:167], a[164:167], a[36:39], v[164:167]
    s_barrier
    v_mfma_f32_16x16x32_bf16 v[164:167], a[168:171], a[40:43], v[164:167]
    s_add_u32 m0, s25, 114688
    ds_read_b64_tr_b16 a[192:193], v218 offset:16384
    ds_read_b64_tr_b16 a[194:195], v218 offset:24576
    v_fma_f32 v160, v160, s24, -v209
    v_mfma_f32_16x16x32_bf16 v[164:167], a[172:175], a[44:47], v[164:167]
    buffer_load_dwordx4 v232, s[16:19], s27 offen offset:0 nt lds
    ds_read_b64_tr_b16 a[196:197], v219 offset:16384
    v_fma_f32 v161, v161, s24, -v209
    v_mfma_f32_16x16x32_bf16 v[164:167], a[176:179], a[48:51], v[164:167]
    v_exp_f32 v160, v160
    v_mfma_f32_16x16x32_bf16 v[164:167], a[180:183], a[52:55], v[164:167]
    ds_read_b64_tr_b16 a[198:199], v219 offset:24576
    ds_read_b128 v[180:183], v227 offset:10240
    v_fma_f32 v162, v162, s24, -v209
    v_mfma_f32_16x16x32_bf16 v[164:167], a[184:187], a[56:59], v[164:167]
    v_exp_f32 v161, v161
    v_mfma_f32_16x16x32_bf16 v[164:167], a[188:191], a[60:63], v[164:167]
    buffer_load_dwordx4 v233, s[16:19], s27 offen offset:1024 nt lds
    ds_read_b64_tr_b16 a[200:201], v220 offset:16384
    v_fma_f32 v163, v163, s24, -v209
    v_mfma_f32_16x16x32_bf16 v[168:171], a[160:163], a[64:67], 0
    v_exp_f32 v162, v162
    v_mfma_f32_16x16x32_bf16 v[168:171], a[164:167], a[68:71], v[168:171]
    ds_read_b64_tr_b16 a[202:203], v220 offset:24576
    ds_read_b64_tr_b16 a[204:205], v221 offset:16384
    v_cvt_pk_bf16_f32 v200, v160, v161
    v_mfma_f32_16x16x32_bf16 v[168:171], a[168:171], a[72:75], v[168:171]
    v_exp_f32 v163, v163
    v_mfma_f32_16x16x32_bf16 v[168:171], a[172:175], a[76:79], v[168:171]
    buffer_load_dwordx4 v234, s[16:19], s27 offen offset:2048 nt lds
    ds_read_b64_tr_b16 a[206:207], v221 offset:24576
    v_mfma_f32_16x16x32_bf16 v[168:171], a[176:179], a[80:83], v[168:171]
    ds_read_b64_tr_b16 a[208:209], v222 offset:16384
    ds_read_b64_tr_b16 a[210:211], v222 offset:24576
    v_cvt_pk_bf16_f32 v201, v162, v163
    v_mfma_f32_16x16x32_bf16 v[168:171], a[180:183], a[84:87], v[168:171]
    ds_write_b64 v226, v[200:201] offset:0
    ds_read_b64_tr_b16 a[212:213], v223 offset:16384
    v_add_f32 v204, v204, v160
    v_mfma_f32_16x16x32_bf16 v[168:171], a[184:187], a[88:91], v[168:171]
    buffer_load_dwordx4 v235, s[16:19], s27 offen offset:3072 nt lds
    ds_read_b64_tr_b16 a[214:215], v223 offset:24576
    v_add_f32 v204, v204, v161
    v_mfma_f32_16x16x32_bf16 v[168:171], a[188:191], a[92:95], v[168:171]
    s_add_u32 s27, s27, 16384
    s_and_b32 s27, s27, 0x7ffff
    ds_read_b64_tr_b16 a[216:217], v224 offset:16384
    ds_read_b64_tr_b16 a[218:219], v224 offset:24576
    v_add_f32 v204, v204, v162
    v_mfma_f32_16x16x32_bf16 v[172:175], a[160:163], a[96:99], 0
    ds_read_b64_tr_b16 a[220:221], v225 offset:16384
    ds_read_b64_tr_b16 a[222:223], v225 offset:24576
    v_add_f32 v204, v204, v163
    v_mfma_f32_16x16x32_bf16 v[172:175], a[164:167], a[100:103], v[172:175]
    s_add_u32 m0, s25, 16384
    v_mfma_f32_16x16x32_bf16 v[172:175], a[168:171], a[104:107], v[172:175]
    buffer_load_dwordx4 v228, s[12:15], s26 offen offset:0 nt lds
    ds_read_b128 v[184:187], v227 offset:11264
    v_fma_f32 v164, v164, s24, -v210
    v_mfma_f32_16x16x32_bf16 v[172:175], a[172:175], a[108:111], v[172:175]
    v_fma_f32 v165, v165, s24, -v210
    v_mfma_f32_16x16x32_bf16 v[172:175], a[176:179], a[112:115], v[172:175]
    v_exp_f32 v164, v164
    v_mfma_f32_16x16x32_bf16 v[172:175], a[180:183], a[116:119], v[172:175]
    v_fma_f32 v166, v166, s24, -v210
    v_mfma_f32_16x16x32_bf16 v[172:175], a[184:187], a[120:123], v[172:175]
    v_exp_f32 v165, v165
    v_mfma_f32_16x16x32_bf16 v[172:175], a[188:191], a[124:127], v[172:175]
    s_waitcnt lgkmcnt(1)
    buffer_load_dwordx4 v229, s[12:15], s26 offen offset:1024 nt lds
    v_fma_f32 v167, v167, s24, -v210
    v_mfma_f32_16x16x32_bf16 v[0:3], a[192:195], v[180:183], v[0:3]
    v_exp_f32 v166, v166
    v_mfma_f32_16x16x32_bf16 v[4:7], a[196:199], v[180:183], v[4:7]
    v_cvt_pk_bf16_f32 v202, v164, v165
    v_mfma_f32_16x16x32_bf16 v[8:11], a[200:203], v[180:183], v[8:11]
    v_exp_f32 v167, v167
    v_mfma_f32_16x16x32_bf16 v[12:15], a[204:207], v[180:183], v[12:15]
    buffer_load_dwordx4 v230, s[12:15], s26 offen offset:2048 nt lds
    ds_read_b128 v[188:191], v227 offset:12288
    v_mfma_f32_16x16x32_bf16 v[16:19], a[208:211], v[180:183], v[16:19]
    v_cvt_pk_bf16_f32 v203, v166, v167
    v_mfma_f32_16x16x32_bf16 v[20:23], a[212:215], v[180:183], v[20:23]
    ds_write_b64 v226, v[202:203] offset:1024
    v_add_f32 v205, v205, v164
    v_mfma_f32_16x16x32_bf16 v[24:27], a[216:219], v[180:183], v[24:27]
    s_waitcnt vmcnt(15)
    buffer_load_dwordx4 v231, s[12:15], s26 offen offset:3072 nt lds
    v_add_f32 v205, v205, v165
    v_mfma_f32_16x16x32_bf16 v[28:31], a[220:223], v[180:183], v[28:31]
    s_barrier
    s_waitcnt lgkmcnt(2)
    s_add_u32 s26, s26, 16384
    s_and_b32 s26, s26, 0x7ffff
    v_add_f32 v205, v205, v166
    v_mfma_f32_16x16x32_bf16 v[32:35], a[192:195], v[184:187], v[32:35]
    ds_read_b128 a[160:163], v214 offset:49152
    ds_read_b128 a[164:167], v215 offset:49152
    v_add_f32 v205, v205, v167
    v_mfma_f32_16x16x32_bf16 v[36:39], a[196:199], v[184:187], v[36:39]
    s_add_u32 m0, s25, 65536
    ds_read_b128 a[168:171], v216 offset:49152
    ds_read_b128 a[172:175], v217 offset:49152
    v_mfma_f32_16x16x32_bf16 v[40:43], a[200:203], v[184:187], v[40:43]
    buffer_load_dwordx4 v232, s[16:19], s27 offen offset:0 nt lds
    ds_read_b128 v[192:195], v227 offset:13312
    v_fma_f32 v168, v168, s24, -v211
    v_mfma_f32_16x16x32_bf16 v[44:47], a[204:207], v[184:187], v[44:47]
    ds_read_b128 a[176:179], v214 offset:49408
    ds_read_b128 a[180:183], v215 offset:49408
    v_fma_f32 v169, v169, s24, -v211
    v_mfma_f32_16x16x32_bf16 v[48:51], a[208:211], v[184:187], v[48:51]
    v_exp_f32 v168, v168
    v_mfma_f32_16x16x32_bf16 v[52:55], a[212:215], v[184:187], v[52:55]
    ds_read_b128 a[184:187], v216 offset:49408
    ds_read_b128 a[188:191], v217 offset:49408
    v_fma_f32 v170, v170, s24, -v211
    v_mfma_f32_16x16x32_bf16 v[56:59], a[216:219], v[184:187], v[56:59]
    v_exp_f32 v169, v169
    v_mfma_f32_16x16x32_bf16 v[60:63], a[220:223], v[184:187], v[60:63]
    s_waitcnt lgkmcnt(7)
    buffer_load_dwordx4 v233, s[16:19], s27 offen offset:1024 nt lds
    v_fma_f32 v171, v171, s24, -v211
    v_mfma_f32_16x16x32_bf16 v[64:67], a[192:195], v[188:191], v[64:67]
    v_exp_f32 v170, v170
    v_mfma_f32_16x16x32_bf16 v[68:71], a[196:199], v[188:191], v[68:71]
    v_cvt_pk_bf16_f32 v200, v168, v169
    v_mfma_f32_16x16x32_bf16 v[72:75], a[200:203], v[188:191], v[72:75]
    v_exp_f32 v171, v171
    v_mfma_f32_16x16x32_bf16 v[76:79], a[204:207], v[188:191], v[76:79]
    buffer_load_dwordx4 v234, s[16:19], s27 offen offset:2048 nt lds
    v_mfma_f32_16x16x32_bf16 v[80:83], a[208:211], v[188:191], v[80:83]
    v_cvt_pk_bf16_f32 v201, v170, v171
    v_mfma_f32_16x16x32_bf16 v[84:87], a[212:215], v[188:191], v[84:87]
    ds_write_b64 v226, v[200:201] offset:2048
    v_add_f32 v206, v206, v168
    v_mfma_f32_16x16x32_bf16 v[88:91], a[216:219], v[188:191], v[88:91]
    buffer_load_dwordx4 v235, s[16:19], s27 offen offset:3072 nt lds
    v_add_f32 v206, v206, v169
    v_mfma_f32_16x16x32_bf16 v[92:95], a[220:223], v[188:191], v[92:95]
    s_waitcnt lgkmcnt(1)
    s_add_u32 s27, s27, 16384
    s_and_b32 s27, s27, 0x7ffff
    v_add_f32 v206, v206, v170
    v_mfma_f32_16x16x32_bf16 v[96:99], a[192:195], v[192:195], v[96:99]
    v_add_f32 v206, v206, v171
    v_mfma_f32_16x16x32_bf16 v[100:103], a[196:199], v[192:195], v[100:103]
    v_mfma_f32_16x16x32_bf16 v[104:107], a[200:203], v[192:195], v[104:107]
    v_fma_f32 v172, v172, s24, -v212
    v_mfma_f32_16x16x32_bf16 v[108:111], a[204:207], v[192:195], v[108:111]
    v_fma_f32 v173, v173, s24, -v212
    v_mfma_f32_16x16x32_bf16 v[112:115], a[208:211], v[192:195], v[112:115]
    v_exp_f32 v172, v172
    v_mfma_f32_16x16x32_bf16 v[116:119], a[212:215], v[192:195], v[116:119]
    v_fma_f32 v174, v174, s24, -v212
    v_mfma_f32_16x16x32_bf16 v[120:123], a[216:219], v[192:195], v[120:123]
    v_exp_f32 v173, v173
    v_mfma_f32_16x16x32_bf16 v[124:127], a[220:223], v[192:195], v[124:127]
    v_fma_f32 v175, v175, s24, -v212
    s_waitcnt lgkmcnt(0)
    s_mov_b32 s28, 0
L_loop_n4:
    v_mfma_f32_16x16x32_bf16 v[160:163], a[160:163], a[0:3], 0
    v_exp_f32 v174, v174
    v_mfma_f32_16x16x32_bf16 v[160:163], a[164:167], a[4:7], v[160:163]
    v_cvt_pk_bf16_f32 v202, v172, v173
    v_mfma_f32_16x16x32_bf16 v[160:163], a[168:171], a[8:11], v[160:163]
    v_exp_f32 v175, v175
    v_mfma_f32_16x16x32_bf16 v[160:163], a[172:175], a[12:15], v[160:163]
    v_mfma_f32_16x16x32_bf16 v[160:163], a[176:179], a[16:19], v[160:163]
    s_waitcnt lgkmcnt(0)
    v_cvt_pk_bf16_f32 v203, v174, v175
    v_mfma_f32_16x16x32_bf16 v[160:163], a[180:183], a[20:23], v[160:163]
    ds_write_b64 v226, v[202:203] offset:3072
    v_add_f32 v207, v207, v172
    v_mfma_f32_16x16x32_bf16 v[160:163], a[184:187], a[24:27], v[160:163]
    v_add_f32 v207, v207, v173
    v_mfma_f32_16x16x32_bf16 v[160:163], a[188:191], a[28:31], v[160:163]
    v_add_f32 v207, v207, v174
    v_mfma_f32_16x16x32_bf16 v[164:167], a[160:163], a[32:35], 0
    s_waitcnt vmcnt(16)
    v_add_f32 v207, v207, v175
    v_mfma_f32_16x16x32_bf16 v[164:167], a[164:167], a[36:39], v[164:167]
    s_barrier
    v_mfma_f32_16x16x32_bf16 v[164:167], a[168:171], a[40:43], v[164:167]
    s_add_u32 m0, s25, 32768
    ds_read_b64_tr_b16 a[192:193], v218 offset:32768
    v_fma_f32 v160, v160, s24, -v209
    v_mfma_f32_16x16x32_bf16 v[164:167], a[172:175], a[44:47], v[164:167]
    buffer_load_dwordx4 v228, s[12:15], s26 offen offset:0 nt lds
    ds_read_b64_tr_b16 a[194:195], v218 offset:40960
    v_fma_f32 v161, v161, s24, -v209
    v_mfma_f32_16x16x32_bf16 v[164:167], a[176:179], a[48:51], v[164:167]
    v_exp_f32 v160, v160
    v_mfma_f32_16x16x32_bf16 v[164:167], a[180:183], a[52:55], v[164:167]
    ds_read_b64_tr_b16 a[196:197], v219 offset:32768
    v_fma_f32 v162, v162, s24, -v209
    v_mfma_f32_16x16x32_bf16 v[164:167], a[184:187], a[56:59], v[164:167]
    v_exp_f32 v161, v161
    v_mfma_f32_16x16x32_bf16 v[164:167], a[188:191], a[60:63], v[164:167]
    ds_read_b64_tr_b16 a[198:199], v219 offset:40960
    v_fma_f32 v163, v163, s24, -v209
    v_mfma_f32_16x16x32_bf16 v[168:171], a[160:163], a[64:67], 0
    v_exp_f32 v162, v162
    v_mfma_f32_16x16x32_bf16 v[168:171], a[164:167], a[68:71], v[168:171]
    ds_read_b128 v[180:183], v227 offset:0
    v_cvt_pk_bf16_f32 v200, v160, v161
    v_mfma_f32_16x16x32_bf16 v[168:171], a[168:171], a[72:75], v[168:171]
    v_exp_f32 v163, v163
    v_mfma_f32_16x16x32_bf16 v[168:171], a[172:175], a[76:79], v[168:171]
    buffer_load_dwordx4 v229, s[12:15], s26 offen offset:1024 nt lds
    ds_read_b64_tr_b16 a[200:201], v220 offset:32768
    v_mfma_f32_16x16x32_bf16 v[168:171], a[176:179], a[80:83], v[168:171]
    ds_read_b64_tr_b16 a[202:203], v220 offset:40960
    v_cvt_pk_bf16_f32 v201, v162, v163
    v_mfma_f32_16x16x32_bf16 v[168:171], a[180:183], a[84:87], v[168:171]
    ds_write_b64 v226, v[200:201] offset:10240
    v_add_f32 v204, v204, v160
    v_mfma_f32_16x16x32_bf16 v[168:171], a[184:187], a[88:91], v[168:171]
    ds_read_b64_tr_b16 a[204:205], v221 offset:32768
    v_add_f32 v204, v204, v161
    v_mfma_f32_16x16x32_bf16 v[168:171], a[188:191], a[92:95], v[168:171]
    ds_read_b64_tr_b16 a[206:207], v221 offset:40960
    v_add_f32 v204, v204, v162
    v_mfma_f32_16x16x32_bf16 v[172:175], a[160:163], a[96:99], 0
    buffer_load_dwordx4 v230, s[12:15], s26 offen offset:2048 nt lds
    ds_read_b64_tr_b16 a[208:209], v222 offset:32768
    v_add_f32 v204, v204, v163
    v_mfma_f32_16x16x32_bf16 v[172:175], a[164:167], a[100:103], v[172:175]
    ds_read_b64_tr_b16 a[210:211], v222 offset:40960
    v_mfma_f32_16x16x32_bf16 v[172:175], a[168:171], a[104:107], v[172:175]
    ds_read_b64_tr_b16 a[212:213], v223 offset:32768
    v_fma_f32 v164, v164, s24, -v210
    v_mfma_f32_16x16x32_bf16 v[172:175], a[172:175], a[108:111], v[172:175]
    ds_read_b64_tr_b16 a[214:215], v223 offset:40960
    v_fma_f32 v165, v165, s24, -v210
    v_mfma_f32_16x16x32_bf16 v[172:175], a[176:179], a[112:115], v[172:175]
    v_exp_f32 v164, v164
    v_mfma_f32_16x16x32_bf16 v[172:175], a[180:183], a[116:119], v[172:175]
    ds_read_b64_tr_b16 a[216:217], v224 offset:32768
    v_fma_f32 v166, v166, s24, -v210
    v_mfma_f32_16x16x32_bf16 v[172:175], a[184:187], a[120:123], v[172:175]
    v_exp_f32 v165, v165
    v_mfma_f32_16x16x32_bf16 v[172:175], a[188:191], a[124:127], v[172:175]
    s_waitcnt lgkmcnt(4)
    buffer_load_dwordx4 v231, s[12:15], s26 offen offset:3072 nt lds
    ds_read_b64_tr_b16 a[218:219], v224 offset:40960
    v_fma_f32 v167, v167, s24, -v210
    v_mfma_f32_16x16x32_bf16 v[0:3], a[192:195], v[180:183], v[0:3]
    s_add_u32 s26, s26, 16384
    v_exp_f32 v166, v166
    v_mfma_f32_16x16x32_bf16 v[4:7], a[196:199], v[180:183], v[4:7]
    s_and_b32 s26, s26, 0x7ffff
    ds_read_b64_tr_b16 a[220:221], v225 offset:32768
    v_cvt_pk_bf16_f32 v202, v164, v165
    v_mfma_f32_16x16x32_bf16 v[8:11], a[200:203], v[180:183], v[8:11]
    v_exp_f32 v167, v167
    v_mfma_f32_16x16x32_bf16 v[12:15], a[204:207], v[180:183], v[12:15]
    s_waitcnt lgkmcnt(3)
    ds_read_b64_tr_b16 a[222:223], v225 offset:40960
    v_mfma_f32_16x16x32_bf16 v[16:19], a[208:211], v[180:183], v[16:19]
    ds_read_b128 v[184:187], v227 offset:1024
    v_cvt_pk_bf16_f32 v203, v166, v167
    v_mfma_f32_16x16x32_bf16 v[20:23], a[212:215], v[180:183], v[20:23]
    s_waitcnt lgkmcnt(3)
    ds_write_b64 v226, v[202:203] offset:11264
    v_add_f32 v205, v205, v164
    v_mfma_f32_16x16x32_bf16 v[24:27], a[216:219], v[180:183], v[24:27]
    s_waitcnt vmcnt(16) lgkmcnt(2)
    ds_read_b128 v[188:191], v227 offset:2048
    v_add_f32 v205, v205, v165
    v_mfma_f32_16x16x32_bf16 v[28:31], a[220:223], v[180:183], v[28:31]
    s_barrier
    s_waitcnt lgkmcnt(2)
    v_add_f32 v205, v205, v166
    v_mfma_f32_16x16x32_bf16 v[32:35], a[192:195], v[184:187], v[32:35]
    s_add_u32 m0, s25, 81920
    ds_read_b128 a[160:163], v214 offset:0
    v_add_f32 v205, v205, v167
    v_mfma_f32_16x16x32_bf16 v[36:39], a[196:199], v[184:187], v[36:39]
    buffer_load_dwordx4 v232, s[16:19], s27 offen offset:0 nt lds
    ds_read_b128 a[164:167], v215 offset:0
    v_mfma_f32_16x16x32_bf16 v[40:43], a[200:203], v[184:187], v[40:43]
    ds_read_b128 v[192:195], v227 offset:3072
    v_fma_f32 v168, v168, s24, -v211
    v_mfma_f32_16x16x32_bf16 v[44:47], a[204:207], v[184:187], v[44:47]
    ds_read_b128 a[168:171], v216 offset:0
    v_fma_f32 v169, v169, s24, -v211
    v_mfma_f32_16x16x32_bf16 v[48:51], a[208:211], v[184:187], v[48:51]
    v_exp_f32 v168, v168
    v_mfma_f32_16x16x32_bf16 v[52:55], a[212:215], v[184:187], v[52:55]
    ds_read_b128 a[172:175], v217 offset:0
    v_fma_f32 v170, v170, s24, -v211
    v_mfma_f32_16x16x32_bf16 v[56:59], a[216:219], v[184:187], v[56:59]
    v_exp_f32 v169, v169
    v_mfma_f32_16x16x32_bf16 v[60:63], a[220:223], v[184:187], v[60:63]
    s_waitcnt lgkmcnt(4)
    buffer_load_dwordx4 v233, s[16:19], s27 offen offset:1024 nt lds
    ds_read_b128 a[176:179], v214 offset:256
    v_fma_f32 v171, v171, s24, -v211
    v_mfma_f32_16x16x32_bf16 v[64:67], a[192:195], v[188:191], v[64:67]
    v_exp_f32 v170, v170
    v_mfma_f32_16x16x32_bf16 v[68:71], a[196:199], v[188:191], v[68:71]
    ds_read_b128 a[180:183], v215 offset:256
    v_cvt_pk_bf16_f32 v200, v168, v169
    v_mfma_f32_16x16x32_bf16 v[72:75], a[200:203], v[188:191], v[72:75]
    v_exp_f32 v171, v171
    v_mfma_f32_16x16x32_bf16 v[76:79], a[204:207], v[188:191], v[76:79]
    ds_read_b128 a[184:187], v216 offset:256
    v_mfma_f32_16x16x32_bf16 v[80:83], a[208:211], v[188:191], v[80:83]
    ds_read_b128 a[188:191], v217 offset:256
    v_cvt_pk_bf16_f32 v201, v170, v171
    v_mfma_f32_16x16x32_bf16 v[84:87], a[212:215], v[188:191], v[84:87]
    buffer_load_dwordx4 v234, s[16:19], s27 offen offset:2048 nt lds
    ds_write_b64 v226, v[200:201] offset:12288
    v_add_f32 v206, v206, v168
    v_mfma_f32_16x16x32_bf16 v[88:91], a[216:219], v[188:191], v[88:91]
    v_add_f32 v206, v206, v169
    v_mfma_f32_16x16x32_bf16 v[92:95], a[220:223], v[188:191], v[92:95]
    s_waitcnt lgkmcnt(4)
    v_add_f32 v206, v206, v170
    v_mfma_f32_16x16x32_bf16 v[96:99], a[192:195], v[192:195], v[96:99]
    v_add_f32 v206, v206, v171
    v_mfma_f32_16x16x32_bf16 v[100:103], a[196:199], v[192:195], v[100:103]
    buffer_load_dwordx4 v235, s[16:19], s27 offen offset:3072 nt lds
    v_mfma_f32_16x16x32_bf16 v[104:107], a[200:203], v[192:195], v[104:107]
    s_add_u32 s27, s27, 16384
    v_fma_f32 v172, v172, s24, -v212
    v_mfma_f32_16x16x32_bf16 v[108:111], a[204:207], v[192:195], v[108:111]
    s_and_b32 s27, s27, 0x7ffff
    v_fma_f32 v173, v173, s24, -v212
    v_mfma_f32_16x16x32_bf16 v[112:115], a[208:211], v[192:195], v[112:115]
    v_exp_f32 v172, v172
    v_mfma_f32_16x16x32_bf16 v[116:119], a[212:215], v[192:195], v[116:119]
    v_fma_f32 v174, v174, s24, -v212
    v_mfma_f32_16x16x32_bf16 v[120:123], a[216:219], v[192:195], v[120:123]
    v_exp_f32 v173, v173
    v_mfma_f32_16x16x32_bf16 v[124:127], a[220:223], v[192:195], v[124:127]
    v_fma_f32 v175, v175, s24, -v212
    v_mfma_f32_16x16x32_bf16 v[160:163], a[160:163], a[0:3], 0
    v_exp_f32 v174, v174
    v_mfma_f32_16x16x32_bf16 v[160:163], a[164:167], a[4:7], v[160:163]
    v_cvt_pk_bf16_f32 v202, v172, v173
    v_mfma_f32_16x16x32_bf16 v[160:163], a[168:171], a[8:11], v[160:163]
    v_exp_f32 v175, v175
    v_mfma_f32_16x16x32_bf16 v[160:163], a[172:175], a[12:15], v[160:163]
    v_mfma_f32_16x16x32_bf16 v[160:163], a[176:179], a[16:19], v[160:163]
    s_waitcnt lgkmcnt(0)
    v_cvt_pk_bf16_f32 v203, v174, v175
    v_mfma_f32_16x16x32_bf16 v[160:163], a[180:183], a[20:23], v[160:163]
    ds_write_b64 v226, v[202:203] offset:13312
    v_add_f32 v207, v207, v172
    v_mfma_f32_16x16x32_bf16 v[160:163], a[184:187], a[24:27], v[160:163]
    v_add_f32 v207, v207, v173
    v_mfma_f32_16x16x32_bf16 v[160:163], a[188:191], a[28:31], v[160:163]
    v_add_f32 v207, v207, v174
    v_mfma_f32_16x16x32_bf16 v[164:167], a[160:163], a[32:35], 0
    s_waitcnt vmcnt(16)
    v_add_f32 v207, v207, v175
    v_mfma_f32_16x16x32_bf16 v[164:167], a[164:167], a[36:39], v[164:167]
    s_barrier
    v_mfma_f32_16x16x32_bf16 v[164:167], a[168:171], a[40:43], v[164:167]
    s_add_u32 m0, s25, 49152
    ds_read_b64_tr_b16 a[192:193], v218 offset:49152
    v_fma_f32 v160, v160, s24, -v209
    v_mfma_f32_16x16x32_bf16 v[164:167], a[172:175], a[44:47], v[164:167]
    buffer_load_dwordx4 v228, s[12:15], s26 offen offset:0 nt lds
    ds_read_b64_tr_b16 a[194:195], v218 offset:57344
    v_fma_f32 v161, v161, s24, -v209
    v_mfma_f32_16x16x32_bf16 v[164:167], a[176:179], a[48:51], v[164:167]
    v_exp_f32 v160, v160
    v_mfma_f32_16x16x32_bf16 v[164:167], a[180:183], a[52:55], v[164:167]
    ds_read_b64_tr_b16 a[196:197], v219 offset:49152
    v_fma_f32 v162, v162, s24, -v209
    v_mfma_f32_16x16x32_bf16 v[164:167], a[184:187], a[56:59], v[164:167]
    v_exp_f32 v161, v161
    v_mfma_f32_16x16x32_bf16 v[164:167], a[188:191], a[60:63], v[164:167]
    ds_read_b64_tr_b16 a[198:199], v219 offset:57344
    v_fma_f32 v163, v163, s24, -v209
    v_mfma_f32_16x16x32_bf16 v[168:171], a[160:163], a[64:67], 0
    v_exp_f32 v162, v162
    v_mfma_f32_16x16x32_bf16 v[168:171], a[164:167], a[68:71], v[168:171]
    ds_read_b128 v[180:183], v227 offset:10240
    v_cvt_pk_bf16_f32 v200, v160, v161
    v_mfma_f32_16x16x32_bf16 v[168:171], a[168:171], a[72:75], v[168:171]
    v_exp_f32 v163, v163
    v_mfma_f32_16x16x32_bf16 v[168:171], a[172:175], a[76:79], v[168:171]
    buffer_load_dwordx4 v229, s[12:15], s26 offen offset:1024 nt lds
    ds_read_b64_tr_b16 a[200:201], v220 offset:49152
    v_mfma_f32_16x16x32_bf16 v[168:171], a[176:179], a[80:83], v[168:171]
    ds_read_b64_tr_b16 a[202:203], v220 offset:57344
    v_cvt_pk_bf16_f32 v201, v162, v163
    v_mfma_f32_16x16x32_bf16 v[168:171], a[180:183], a[84:87], v[168:171]
    ds_write_b64 v226, v[200:201] offset:0
    v_add_f32 v204, v204, v160
    v_mfma_f32_16x16x32_bf16 v[168:171], a[184:187], a[88:91], v[168:171]
    ds_read_b64_tr_b16 a[204:205], v221 offset:49152
    v_add_f32 v204, v204, v161
    v_mfma_f32_16x16x32_bf16 v[168:171], a[188:191], a[92:95], v[168:171]
    ds_read_b64_tr_b16 a[206:207], v221 offset:57344
    v_add_f32 v204, v204, v162
    v_mfma_f32_16x16x32_bf16 v[172:175], a[160:163], a[96:99], 0
    buffer_load_dwordx4 v230, s[12:15], s26 offen offset:2048 nt lds
    ds_read_b64_tr_b16 a[208:209], v222 offset:49152
    v_add_f32 v204, v204, v163
    v_mfma_f32_16x16x32_bf16 v[172:175], a[164:167], a[100:103], v[172:175]
    ds_read_b64_tr_b16 a[210:211], v222 offset:57344
    v_mfma_f32_16x16x32_bf16 v[172:175], a[168:171], a[104:107], v[172:175]
    ds_read_b64_tr_b16 a[212:213], v223 offset:49152
    v_fma_f32 v164, v164, s24, -v210
    v_mfma_f32_16x16x32_bf16 v[172:175], a[172:175], a[108:111], v[172:175]
    ds_read_b64_tr_b16 a[214:215], v223 offset:57344
    v_fma_f32 v165, v165, s24, -v210
    v_mfma_f32_16x16x32_bf16 v[172:175], a[176:179], a[112:115], v[172:175]
    v_exp_f32 v164, v164
    v_mfma_f32_16x16x32_bf16 v[172:175], a[180:183], a[116:119], v[172:175]
    ds_read_b64_tr_b16 a[216:217], v224 offset:49152
    v_fma_f32 v166, v166, s24, -v210
    v_mfma_f32_16x16x32_bf16 v[172:175], a[184:187], a[120:123], v[172:175]
    v_exp_f32 v165, v165
    v_mfma_f32_16x16x32_bf16 v[172:175], a[188:191], a[124:127], v[172:175]
    s_waitcnt lgkmcnt(4)
    buffer_load_dwordx4 v231, s[12:15], s26 offen offset:3072 nt lds
    ds_read_b64_tr_b16 a[218:219], v224 offset:57344
    v_fma_f32 v167, v167, s24, -v210
    v_mfma_f32_16x16x32_bf16 v[0:3], a[192:195], v[180:183], v[0:3]
    s_add_u32 s26, s26, 16384
    v_exp_f32 v166, v166
    v_mfma_f32_16x16x32_bf16 v[4:7], a[196:199], v[180:183], v[4:7]
    s_and_b32 s26, s26, 0x7ffff
    ds_read_b64_tr_b16 a[220:221], v225 offset:49152
    v_cvt_pk_bf16_f32 v202, v164, v165
    v_mfma_f32_16x16x32_bf16 v[8:11], a[200:203], v[180:183], v[8:11]
    v_exp_f32 v167, v167
    v_mfma_f32_16x16x32_bf16 v[12:15], a[204:207], v[180:183], v[12:15]
    s_waitcnt lgkmcnt(3)
    ds_read_b64_tr_b16 a[222:223], v225 offset:57344
    v_mfma_f32_16x16x32_bf16 v[16:19], a[208:211], v[180:183], v[16:19]
    ds_read_b128 v[184:187], v227 offset:11264
    v_cvt_pk_bf16_f32 v203, v166, v167
    v_mfma_f32_16x16x32_bf16 v[20:23], a[212:215], v[180:183], v[20:23]
    s_waitcnt lgkmcnt(3)
    ds_write_b64 v226, v[202:203] offset:1024
    v_add_f32 v205, v205, v164
    v_mfma_f32_16x16x32_bf16 v[24:27], a[216:219], v[180:183], v[24:27]
    s_waitcnt vmcnt(16) lgkmcnt(2)
    ds_read_b128 v[188:191], v227 offset:12288
    v_add_f32 v205, v205, v165
    v_mfma_f32_16x16x32_bf16 v[28:31], a[220:223], v[180:183], v[28:31]
    s_barrier
    s_waitcnt lgkmcnt(2)
    v_add_f32 v205, v205, v166
    v_mfma_f32_16x16x32_bf16 v[32:35], a[192:195], v[184:187], v[32:35]
    s_add_u32 m0, s25, 98304
    ds_read_b128 a[160:163], v214 offset:16384
    v_add_f32 v205, v205, v167
    v_mfma_f32_16x16x32_bf16 v[36:39], a[196:199], v[184:187], v[36:39]
    buffer_load_dwordx4 v232, s[16:19], s27 offen offset:0 nt lds
    ds_read_b128 a[164:167], v215 offset:16384
    v_mfma_f32_16x16x32_bf16 v[40:43], a[200:203], v[184:187], v[40:43]
    ds_read_b128 v[192:195], v227 offset:13312
    v_fma_f32 v168, v168, s24, -v211
    v_mfma_f32_16x16x32_bf16 v[44:47], a[204:207], v[184:187], v[44:47]
    ds_read_b128 a[168:171], v216 offset:16384
    v_fma_f32 v169, v169, s24, -v211
    v_mfma_f32_16x16x32_bf16 v[48:51], a[208:211], v[184:187], v[48:51]
    v_exp_f32 v168, v168
    v_mfma_f32_16x16x32_bf16 v[52:55], a[212:215], v[184:187], v[52:55]
    ds_read_b128 a[172:175], v217 offset:16384
    v_fma_f32 v170, v170, s24, -v211
    v_mfma_f32_16x16x32_bf16 v[56:59], a[216:219], v[184:187], v[56:59]
    v_exp_f32 v169, v169
    v_mfma_f32_16x16x32_bf16 v[60:63], a[220:223], v[184:187], v[60:63]
    s_waitcnt lgkmcnt(4)
    buffer_load_dwordx4 v233, s[16:19], s27 offen offset:1024 nt lds
    ds_read_b128 a[176:179], v214 offset:16640
    v_fma_f32 v171, v171, s24, -v211
    v_mfma_f32_16x16x32_bf16 v[64:67], a[192:195], v[188:191], v[64:67]
    v_exp_f32 v170, v170
    v_mfma_f32_16x16x32_bf16 v[68:71], a[196:199], v[188:191], v[68:71]
    ds_read_b128 a[180:183], v215 offset:16640
    v_cvt_pk_bf16_f32 v200, v168, v169
    v_mfma_f32_16x16x32_bf16 v[72:75], a[200:203], v[188:191], v[72:75]
    v_exp_f32 v171, v171
    v_mfma_f32_16x16x32_bf16 v[76:79], a[204:207], v[188:191], v[76:79]
    ds_read_b128 a[184:187], v216 offset:16640
    v_mfma_f32_16x16x32_bf16 v[80:83], a[208:211], v[188:191], v[80:83]
    ds_read_b128 a[188:191], v217 offset:16640
    v_cvt_pk_bf16_f32 v201, v170, v171
    v_mfma_f32_16x16x32_bf16 v[84:87], a[212:215], v[188:191], v[84:87]
    buffer_load_dwordx4 v234, s[16:19], s27 offen offset:2048 nt lds
    ds_write_b64 v226, v[200:201] offset:2048
    v_add_f32 v206, v206, v168
    v_mfma_f32_16x16x32_bf16 v[88:91], a[216:219], v[188:191], v[88:91]
    v_add_f32 v206, v206, v169
    v_mfma_f32_16x16x32_bf16 v[92:95], a[220:223], v[188:191], v[92:95]
    s_waitcnt lgkmcnt(4)
    v_add_f32 v206, v206, v170
    v_mfma_f32_16x16x32_bf16 v[96:99], a[192:195], v[192:195], v[96:99]
    v_add_f32 v206, v206, v171
    v_mfma_f32_16x16x32_bf16 v[100:103], a[196:199], v[192:195], v[100:103]
    buffer_load_dwordx4 v235, s[16:19], s27 offen offset:3072 nt lds
    v_mfma_f32_16x16x32_bf16 v[104:107], a[200:203], v[192:195], v[104:107]
    s_add_u32 s27, s27, 16384
    v_fma_f32 v172, v172, s24, -v212
    v_mfma_f32_16x16x32_bf16 v[108:111], a[204:207], v[192:195], v[108:111]
    s_and_b32 s27, s27, 0x7ffff
    v_fma_f32 v173, v173, s24, -v212
    v_mfma_f32_16x16x32_bf16 v[112:115], a[208:211], v[192:195], v[112:115]
    v_exp_f32 v172, v172
    v_mfma_f32_16x16x32_bf16 v[116:119], a[212:215], v[192:195], v[116:119]
    v_fma_f32 v174, v174, s24, -v212
    v_mfma_f32_16x16x32_bf16 v[120:123], a[216:219], v[192:195], v[120:123]
    v_exp_f32 v173, v173
    v_mfma_f32_16x16x32_bf16 v[124:127], a[220:223], v[192:195], v[124:127]
    v_fma_f32 v175, v175, s24, -v212
    v_mfma_f32_16x16x32_bf16 v[160:163], a[160:163], a[0:3], 0
    v_exp_f32 v174, v174
    v_mfma_f32_16x16x32_bf16 v[160:163], a[164:167], a[4:7], v[160:163]
    v_cvt_pk_bf16_f32 v202, v172, v173
    v_mfma_f32_16x16x32_bf16 v[160:163], a[168:171], a[8:11], v[160:163]
    v_exp_f32 v175, v175
    v_mfma_f32_16x16x32_bf16 v[160:163], a[172:175], a[12:15], v[160:163]
    v_mfma_f32_16x16x32_bf16 v[160:163], a[176:179], a[16:19], v[160:163]
    s_waitcnt lgkmcnt(0)
    v_cvt_pk_bf16_f32 v203, v174, v175
    v_mfma_f32_16x16x32_bf16 v[160:163], a[180:183], a[20:23], v[160:163]
    ds_write_b64 v226, v[202:203] offset:3072
    v_add_f32 v207, v207, v172
    v_mfma_f32_16x16x32_bf16 v[160:163], a[184:187], a[24:27], v[160:163]
    v_add_f32 v207, v207, v173
    v_mfma_f32_16x16x32_bf16 v[160:163], a[188:191], a[28:31], v[160:163]
    v_add_f32 v207, v207, v174
    v_mfma_f32_16x16x32_bf16 v[164:167], a[160:163], a[32:35], 0
    s_waitcnt vmcnt(16)
    v_add_f32 v207, v207, v175
    v_mfma_f32_16x16x32_bf16 v[164:167], a[164:167], a[36:39], v[164:167]
    s_barrier
    s_cmp_eq_u32 s28, 6
    s_cselect_b32 s14, 0, s14
    v_mfma_f32_16x16x32_bf16 v[164:167], a[168:171], a[40:43], v[164:167]
    s_add_u32 m0, s25, 0
    ds_read_b64_tr_b16 a[192:193], v218 offset:0
    v_fma_f32 v160, v160, s24, -v209
    v_mfma_f32_16x16x32_bf16 v[164:167], a[172:175], a[44:47], v[164:167]
    buffer_load_dwordx4 v228, s[12:15], s26 offen offset:0 nt lds
    ds_read_b64_tr_b16 a[194:195], v218 offset:8192
    v_fma_f32 v161, v161, s24, -v209
    v_mfma_f32_16x16x32_bf16 v[164:167], a[176:179], a[48:51], v[164:167]
    v_exp_f32 v160, v160
    v_mfma_f32_16x16x32_bf16 v[164:167], a[180:183], a[52:55], v[164:167]
    ds_read_b64_tr_b16 a[196:197], v219 offset:0
    v_fma_f32 v162, v162, s24, -v209
    v_mfma_f32_16x16x32_bf16 v[164:167], a[184:187], a[56:59], v[164:167]
    v_exp_f32 v161, v161
    v_mfma_f32_16x16x32_bf16 v[164:167], a[188:191], a[60:63], v[164:167]
    ds_read_b64_tr_b16 a[198:199], v219 offset:8192
    v_fma_f32 v163, v163, s24, -v209
    v_mfma_f32_16x16x32_bf16 v[168:171], a[160:163], a[64:67], 0
    v_exp_f32 v162, v162
    v_mfma_f32_16x16x32_bf16 v[168:171], a[164:167], a[68:71], v[168:171]
    ds_read_b128 v[180:183], v227 offset:0
    v_cvt_pk_bf16_f32 v200, v160, v161
    v_mfma_f32_16x16x32_bf16 v[168:171], a[168:171], a[72:75], v[168:171]
    v_exp_f32 v163, v163
    v_mfma_f32_16x16x32_bf16 v[168:171], a[172:175], a[76:79], v[168:171]
    buffer_load_dwordx4 v229, s[12:15], s26 offen offset:1024 nt lds
    ds_read_b64_tr_b16 a[200:201], v220 offset:0
    v_mfma_f32_16x16x32_bf16 v[168:171], a[176:179], a[80:83], v[168:171]
    ds_read_b64_tr_b16 a[202:203], v220 offset:8192
    v_cvt_pk_bf16_f32 v201, v162, v163
    v_mfma_f32_16x16x32_bf16 v[168:171], a[180:183], a[84:87], v[168:171]
    ds_write_b64 v226, v[200:201] offset:10240
    v_add_f32 v204, v204, v160
    v_mfma_f32_16x16x32_bf16 v[168:171], a[184:187], a[88:91], v[168:171]
    ds_read_b64_tr_b16 a[204:205], v221 offset:0
    v_add_f32 v204, v204, v161
    v_mfma_f32_16x16x32_bf16 v[168:171], a[188:191], a[92:95], v[168:171]
    ds_read_b64_tr_b16 a[206:207], v221 offset:8192
    v_add_f32 v204, v204, v162
    v_mfma_f32_16x16x32_bf16 v[172:175], a[160:163], a[96:99], 0
    buffer_load_dwordx4 v230, s[12:15], s26 offen offset:2048 nt lds
    ds_read_b64_tr_b16 a[208:209], v222 offset:0
    v_add_f32 v204, v204, v163
    v_mfma_f32_16x16x32_bf16 v[172:175], a[164:167], a[100:103], v[172:175]
    ds_read_b64_tr_b16 a[210:211], v222 offset:8192
    v_mfma_f32_16x16x32_bf16 v[172:175], a[168:171], a[104:107], v[172:175]
    ds_read_b64_tr_b16 a[212:213], v223 offset:0
    v_fma_f32 v164, v164, s24, -v210
    v_mfma_f32_16x16x32_bf16 v[172:175], a[172:175], a[108:111], v[172:175]
    ds_read_b64_tr_b16 a[214:215], v223 offset:8192
    v_fma_f32 v165, v165, s24, -v210
    v_mfma_f32_16x16x32_bf16 v[172:175], a[176:179], a[112:115], v[172:175]
    v_exp_f32 v164, v164
    v_mfma_f32_16x16x32_bf16 v[172:175], a[180:183], a[116:119], v[172:175]
    ds_read_b64_tr_b16 a[216:217], v224 offset:0
    v_fma_f32 v166, v166, s24, -v210
    v_mfma_f32_16x16x32_bf16 v[172:175], a[184:187], a[120:123], v[172:175]
    v_exp_f32 v165, v165
    v_mfma_f32_16x16x32_bf16 v[172:175], a[188:191], a[124:127], v[172:175]
    s_waitcnt lgkmcnt(4)
    buffer_load_dwordx4 v231, s[12:15], s26 offen offset:3072 nt lds
    ds_read_b64_tr_b16 a[218:219], v224 offset:8192
    v_fma_f32 v167, v167, s24, -v210
    v_mfma_f32_16x16x32_bf16 v[0:3], a[192:195], v[180:183], v[0:3]
    s_add_u32 s26, s26, 16384
    v_exp_f32 v166, v166
    v_mfma_f32_16x16x32_bf16 v[4:7], a[196:199], v[180:183], v[4:7]
    s_and_b32 s26, s26, 0x7ffff
    ds_read_b64_tr_b16 a[220:221], v225 offset:0
    v_cvt_pk_bf16_f32 v202, v164, v165
    v_mfma_f32_16x16x32_bf16 v[8:11], a[200:203], v[180:183], v[8:11]
    v_exp_f32 v167, v167
    v_mfma_f32_16x16x32_bf16 v[12:15], a[204:207], v[180:183], v[12:15]
    s_waitcnt lgkmcnt(3)
    ds_read_b64_tr_b16 a[222:223], v225 offset:8192
    v_mfma_f32_16x16x32_bf16 v[16:19], a[208:211], v[180:183], v[16:19]
    ds_read_b128 v[184:187], v227 offset:1024
    v_cvt_pk_bf16_f32 v203, v166, v167
    v_mfma_f32_16x16x32_bf16 v[20:23], a[212:215], v[180:183], v[20:23]
    s_waitcnt lgkmcnt(3)
    ds_write_b64 v226, v[202:203] offset:11264
    v_add_f32 v205, v205, v164
    v_mfma_f32_16x16x32_bf16 v[24:27], a[216:219], v[180:183], v[24:27]
    s_waitcnt vmcnt(16) lgkmcnt(2)
    ds_read_b128 v[188:191], v227 offset:2048
    v_add_f32 v205, v205, v165
    v_mfma_f32_16x16x32_bf16 v[28:31], a[220:223], v[180:183], v[28:31]
    s_barrier
    s_waitcnt lgkmcnt(2)
    v_add_f32 v205, v205, v166
    v_mfma_f32_16x16x32_bf16 v[32:35], a[192:195], v[184:187], v[32:35]
    s_add_u32 m0, s25, 114688
    ds_read_b128 a[160:163], v214 offset:32768
    v_add_f32 v205, v205, v167
    v_mfma_f32_16x16x32_bf16 v[36:39], a[196:199], v[184:187], v[36:39]
    buffer_load_dwordx4 v232, s[16:19], s27 offen offset:0 nt lds
    ds_read_b128 a[164:167], v215 offset:32768
    v_mfma_f32_16x16x32_bf16 v[40:43], a[200:203], v[184:187], v[40:43]
    ds_read_b128 v[192:195], v227 offset:3072
    v_fma_f32 v168, v168, s24, -v211
    v_mfma_f32_16x16x32_bf16 v[44:47], a[204:207], v[184:187], v[44:47]
    ds_read_b128 a[168:171], v216 offset:32768
    v_fma_f32 v169, v169, s24, -v211
    v_mfma_f32_16x16x32_bf16 v[48:51], a[208:211], v[184:187], v[48:51]
    v_exp_f32 v168, v168
    v_mfma_f32_16x16x32_bf16 v[52:55], a[212:215], v[184:187], v[52:55]
    ds_read_b128 a[172:175], v217 offset:32768
    v_fma_f32 v170, v170, s24, -v211
    v_mfma_f32_16x16x32_bf16 v[56:59], a[216:219], v[184:187], v[56:59]
    v_exp_f32 v169, v169
    v_mfma_f32_16x16x32_bf16 v[60:63], a[220:223], v[184:187], v[60:63]
    s_waitcnt lgkmcnt(4)
    buffer_load_dwordx4 v233, s[16:19], s27 offen offset:1024 nt lds
    ds_read_b128 a[176:179], v214 offset:33024
    v_fma_f32 v171, v171, s24, -v211
    v_mfma_f32_16x16x32_bf16 v[64:67], a[192:195], v[188:191], v[64:67]
    v_exp_f32 v170, v170
    v_mfma_f32_16x16x32_bf16 v[68:71], a[196:199], v[188:191], v[68:71]
    ds_read_b128 a[180:183], v215 offset:33024
    v_cvt_pk_bf16_f32 v200, v168, v169
    v_mfma_f32_16x16x32_bf16 v[72:75], a[200:203], v[188:191], v[72:75]
    v_exp_f32 v171, v171
    v_mfma_f32_16x16x32_bf16 v[76:79], a[204:207], v[188:191], v[76:79]
    ds_read_b128 a[184:187], v216 offset:33024
    v_mfma_f32_16x16x32_bf16 v[80:83], a[208:211], v[188:191], v[80:83]
    ds_read_b128 a[188:191], v217 offset:33024
    v_cvt_pk_bf16_f32 v201, v170, v171
    v_mfma_f32_16x16x32_bf16 v[84:87], a[212:215], v[188:191], v[84:87]
    buffer_load_dwordx4 v234, s[16:19], s27 offen offset:2048 nt lds
    ds_write_b64 v226, v[200:201] offset:12288
    v_add_f32 v206, v206, v168
    v_mfma_f32_16x16x32_bf16 v[88:91], a[216:219], v[188:191], v[88:91]
    v_add_f32 v206, v206, v169
    v_mfma_f32_16x16x32_bf16 v[92:95], a[220:223], v[188:191], v[92:95]
    s_waitcnt lgkmcnt(4)
    v_add_f32 v206, v206, v170
    v_mfma_f32_16x16x32_bf16 v[96:99], a[192:195], v[192:195], v[96:99]
    v_add_f32 v206, v206, v171
    v_mfma_f32_16x16x32_bf16 v[100:103], a[196:199], v[192:195], v[100:103]
    buffer_load_dwordx4 v235, s[16:19], s27 offen offset:3072 nt lds
    v_mfma_f32_16x16x32_bf16 v[104:107], a[200:203], v[192:195], v[104:107]
    s_add_u32 s27, s27, 16384
    v_fma_f32 v172, v172, s24, -v212
    v_mfma_f32_16x16x32_bf16 v[108:111], a[204:207], v[192:195], v[108:111]
    s_and_b32 s27, s27, 0x7ffff
    v_fma_f32 v173, v173, s24, -v212
    v_mfma_f32_16x16x32_bf16 v[112:115], a[208:211], v[192:195], v[112:115]
    v_exp_f32 v172, v172
    v_mfma_f32_16x16x32_bf16 v[116:119], a[212:215], v[192:195], v[116:119]
    v_fma_f32 v174, v174, s24, -v212
    v_mfma_f32_16x16x32_bf16 v[120:123], a[216:219], v[192:195], v[120:123]
    v_exp_f32 v173, v173
    v_mfma_f32_16x16x32_bf16 v[124:127], a[220:223], v[192:195], v[124:127]
    v_fma_f32 v175, v175, s24, -v212
    v_mfma_f32_16x16x32_bf16 v[160:163], a[160:163], a[0:3], 0
    v_exp_f32 v174, v174
    v_mfma_f32_16x16x32_bf16 v[160:163], a[164:167], a[4:7], v[160:163]
    v_cvt_pk_bf16_f32 v202, v172, v173
    v_mfma_f32_16x16x32_bf16 v[160:163], a[168:171], a[8:11], v[160:163]
    v_exp_f32 v175, v175
    v_mfma_f32_16x16x32_bf16 v[160:163], a[172:175], a[12:15], v[160:163]
    v_mfma_f32_16x16x32_bf16 v[160:163], a[176:179], a[16:19], v[160:163]
    s_waitcnt lgkmcnt(0)
    v_cvt_pk_bf16_f32 v203, v174, v175
    v_mfma_f32_16x16x32_bf16 v[160:163], a[180:183], a[20:23], v[160:163]
    ds_write_b64 v226, v[202:203] offset:13312
    v_add_f32 v207, v207, v172
    v_mfma_f32_16x16x32_bf16 v[160:163], a[184:187], a[24:27], v[160:163]
    v_add_f32 v207, v207, v173
    v_mfma_f32_16x16x32_bf16 v[160:163], a[188:191], a[28:31], v[160:163]
    v_add_f32 v207, v207, v174
    v_mfma_f32_16x16x32_bf16 v[164:167], a[160:163], a[32:35], 0
    s_waitcnt vmcnt(16)
    v_add_f32 v207, v207, v175
    v_mfma_f32_16x16x32_bf16 v[164:167], a[164:167], a[36:39], v[164:167]
    s_barrier
    v_mfma_f32_16x16x32_bf16 v[164:167], a[168:171], a[40:43], v[164:167]
    s_add_u32 m0, s25, 16384
    ds_read_b64_tr_b16 a[192:193], v218 offset:16384
    v_fma_f32 v160, v160, s24, -v209
    v_mfma_f32_16x16x32_bf16 v[164:167], a[172:175], a[44:47], v[164:167]
    buffer_load_dwordx4 v228, s[12:15], s26 offen offset:0 nt lds
    ds_read_b64_tr_b16 a[194:195], v218 offset:24576
    v_fma_f32 v161, v161, s24, -v209
    v_mfma_f32_16x16x32_bf16 v[164:167], a[176:179], a[48:51], v[164:167]
    v_exp_f32 v160, v160
    v_mfma_f32_16x16x32_bf16 v[164:167], a[180:183], a[52:55], v[164:167]
    ds_read_b64_tr_b16 a[196:197], v219 offset:16384
    v_fma_f32 v162, v162, s24, -v209
    v_mfma_f32_16x16x32_bf16 v[164:167], a[184:187], a[56:59], v[164:167]
    v_exp_f32 v161, v161
    v_mfma_f32_16x16x32_bf16 v[164:167], a[188:191], a[60:63], v[164:167]
    ds_read_b64_tr_b16 a[198:199], v219 offset:24576
    v_fma_f32 v163, v163, s24, -v209
    v_mfma_f32_16x16x32_bf16 v[168:171], a[160:163], a[64:67], 0
    v_exp_f32 v162, v162
    v_mfma_f32_16x16x32_bf16 v[168:171], a[164:167], a[68:71], v[168:171]
    ds_read_b128 v[180:183], v227 offset:10240
    v_cvt_pk_bf16_f32 v200, v160, v161
    v_mfma_f32_16x16x32_bf16 v[168:171], a[168:171], a[72:75], v[168:171]
    v_exp_f32 v163, v163
    v_mfma_f32_16x16x32_bf16 v[168:171], a[172:175], a[76:79], v[168:171]
    buffer_load_dwordx4 v229, s[12:15], s26 offen offset:1024 nt lds
    ds_read_b64_tr_b16 a[200:201], v220 offset:16384
    v_mfma_f32_16x16x32_bf16 v[168:171], a[176:179], a[80:83], v[168:171]
    ds_read_b64_tr_b16 a[202:203], v220 offset:24576
    v_cvt_pk_bf16_f32 v201, v162, v163
    v_mfma_f32_16x16x32_bf16 v[168:171], a[180:183], a[84:87], v[168:171]
    ds_write_b64 v226, v[200:201] offset:0
    v_add_f32 v204, v204, v160
    v_mfma_f32_16x16x32_bf16 v[168:171], a[184:187], a[88:91], v[168:171]
    ds_read_b64_tr_b16 a[204:205], v221 offset:16384
    v_add_f32 v204, v204, v161
    v_mfma_f32_16x16x32_bf16 v[168:171], a[188:191], a[92:95], v[168:171]
    ds_read_b64_tr_b16 a[206:207], v221 offset:24576
    v_add_f32 v204, v204, v162
    v_mfma_f32_16x16x32_bf16 v[172:175], a[160:163], a[96:99], 0
    buffer_load_dwordx4 v230, s[12:15], s26 offen offset:2048 nt lds
    ds_read_b64_tr_b16 a[208:209], v222 offset:16384
    v_add_f32 v204, v204, v163
    v_mfma_f32_16x16x32_bf16 v[172:175], a[164:167], a[100:103], v[172:175]
    ds_read_b64_tr_b16 a[210:211], v222 offset:24576
    v_mfma_f32_16x16x32_bf16 v[172:175], a[168:171], a[104:107], v[172:175]
    ds_read_b64_tr_b16 a[212:213], v223 offset:16384
    v_fma_f32 v164, v164, s24, -v210
    v_mfma_f32_16x16x32_bf16 v[172:175], a[172:175], a[108:111], v[172:175]
    ds_read_b64_tr_b16 a[214:215], v223 offset:24576
    v_fma_f32 v165, v165, s24, -v210
    v_mfma_f32_16x16x32_bf16 v[172:175], a[176:179], a[112:115], v[172:175]
    v_exp_f32 v164, v164
    v_mfma_f32_16x16x32_bf16 v[172:175], a[180:183], a[116:119], v[172:175]
    ds_read_b64_tr_b16 a[216:217], v224 offset:16384
    v_fma_f32 v166, v166, s24, -v210
    v_mfma_f32_16x16x32_bf16 v[172:175], a[184:187], a[120:123], v[172:175]
    v_exp_f32 v165, v165
    v_mfma_f32_16x16x32_bf16 v[172:175], a[188:191], a[124:127], v[172:175]
    s_waitcnt lgkmcnt(4)
    buffer_load_dwordx4 v231, s[12:15], s26 offen offset:3072 nt lds
    ds_read_b64_tr_b16 a[218:219], v224 offset:24576
    v_fma_f32 v167, v167, s24, -v210
    v_mfma_f32_16x16x32_bf16 v[0:3], a[192:195], v[180:183], v[0:3]
    s_add_u32 s26, s26, 16384
    v_exp_f32 v166, v166
    v_mfma_f32_16x16x32_bf16 v[4:7], a[196:199], v[180:183], v[4:7]
    s_and_b32 s26, s26, 0x7ffff
    ds_read_b64_tr_b16 a[220:221], v225 offset:16384
    v_cvt_pk_bf16_f32 v202, v164, v165
    v_mfma_f32_16x16x32_bf16 v[8:11], a[200:203], v[180:183], v[8:11]
    v_exp_f32 v167, v167
    v_mfma_f32_16x16x32_bf16 v[12:15], a[204:207], v[180:183], v[12:15]
    s_waitcnt lgkmcnt(3)
    ds_read_b64_tr_b16 a[222:223], v225 offset:24576
    v_mfma_f32_16x16x32_bf16 v[16:19], a[208:211], v[180:183], v[16:19]
    ds_read_b128 v[184:187], v227 offset:11264
    v_cvt_pk_bf16_f32 v203, v166, v167
    v_mfma_f32_16x16x32_bf16 v[20:23], a[212:215], v[180:183], v[20:23]
    s_waitcnt lgkmcnt(3)
    ds_write_b64 v226, v[202:203] offset:1024
    v_add_f32 v205, v205, v164
    v_mfma_f32_16x16x32_bf16 v[24:27], a[216:219], v[180:183], v[24:27]
    s_waitcnt vmcnt(16) lgkmcnt(2)
    ds_read_b128 v[188:191], v227 offset:12288
    v_add_f32 v205, v205, v165
    v_mfma_f32_16x16x32_bf16 v[28:31], a[220:223], v[180:183], v[28:31]
    s_barrier
    s_waitcnt lgkmcnt(2)
    s_cmp_eq_u32 s28, 6
    s_cselect_b32 s18, 0, s18
    v_add_f32 v205, v205, v166
    v_mfma_f32_16x16x32_bf16 v[32:35], a[192:195], v[184:187], v[32:35]
    s_add_u32 m0, s25, 65536
    ds_read_b128 a[160:163], v214 offset:49152
    v_add_f32 v205, v205, v167
    v_mfma_f32_16x16x32_bf16 v[36:39], a[196:199], v[184:187], v[36:39]
    buffer_load_dwordx4 v232, s[16:19], s27 offen offset:0 nt lds
    ds_read_b128 a[164:167], v215 offset:49152
    v_mfma_f32_16x16x32_bf16 v[40:43], a[200:203], v[184:187], v[40:43]
    ds_read_b128 v[192:195], v227 offset:13312
    v_fma_f32 v168, v168, s24, -v211
    v_mfma_f32_16x16x32_bf16 v[44:47], a[204:207], v[184:187], v[44:47]
    ds_read_b128 a[168:171], v216 offset:49152
    v_fma_f32 v169, v169, s24, -v211
    v_mfma_f32_16x16x32_bf16 v[48:51], a[208:211], v[184:187], v[48:51]
    v_exp_f32 v168, v168
    v_mfma_f32_16x16x32_bf16 v[52:55], a[212:215], v[184:187], v[52:55]
    ds_read_b128 a[172:175], v217 offset:49152
    v_fma_f32 v170, v170, s24, -v211
    v_mfma_f32_16x16x32_bf16 v[56:59], a[216:219], v[184:187], v[56:59]
    v_exp_f32 v169, v169
    v_mfma_f32_16x16x32_bf16 v[60:63], a[220:223], v[184:187], v[60:63]
    s_waitcnt lgkmcnt(4)
    buffer_load_dwordx4 v233, s[16:19], s27 offen offset:1024 nt lds
    ds_read_b128 a[176:179], v214 offset:49408
    v_fma_f32 v171, v171, s24, -v211
    v_mfma_f32_16x16x32_bf16 v[64:67], a[192:195], v[188:191], v[64:67]
    v_exp_f32 v170, v170
    v_mfma_f32_16x16x32_bf16 v[68:71], a[196:199], v[188:191], v[68:71]
    ds_read_b128 a[180:183], v215 offset:49408
    v_cvt_pk_bf16_f32 v200, v168, v169
    v_mfma_f32_16x16x32_bf16 v[72:75], a[200:203], v[188:191], v[72:75]
    v_exp_f32 v171, v171
    v_mfma_f32_16x16x32_bf16 v[76:79], a[204:207], v[188:191], v[76:79]
    ds_read_b128 a[184:187], v216 offset:49408
    v_mfma_f32_16x16x32_bf16 v[80:83], a[208:211], v[188:191], v[80:83]
    ds_read_b128 a[188:191], v217 offset:49408
    v_cvt_pk_bf16_f32 v201, v170, v171
    v_mfma_f32_16x16x32_bf16 v[84:87], a[212:215], v[188:191], v[84:87]
    buffer_load_dwordx4 v234, s[16:19], s27 offen offset:2048 nt lds
    ds_write_b64 v226, v[200:201] offset:2048
    v_add_f32 v206, v206, v168
    v_mfma_f32_16x16x32_bf16 v[88:91], a[216:219], v[188:191], v[88:91]
    s_add_u32 s28, s28, 1
    v_add_f32 v206, v206, v169
    v_mfma_f32_16x16x32_bf16 v[92:95], a[220:223], v[188:191], v[92:95]
    s_waitcnt lgkmcnt(4)
    v_add_f32 v206, v206, v170
    v_mfma_f32_16x16x32_bf16 v[96:99], a[192:195], v[192:195], v[96:99]
    v_add_f32 v206, v206, v171
    v_mfma_f32_16x16x32_bf16 v[100:103], a[196:199], v[192:195], v[100:103]
    buffer_load_dwordx4 v235, s[16:19], s27 offen offset:3072 nt lds
    v_mfma_f32_16x16x32_bf16 v[104:107], a[200:203], v[192:195], v[104:107]
    s_add_u32 s27, s27, 16384
    v_fma_f32 v172, v172, s24, -v212
    v_mfma_f32_16x16x32_bf16 v[108:111], a[204:207], v[192:195], v[108:111]
    s_and_b32 s27, s27, 0x7ffff
    v_fma_f32 v173, v173, s24, -v212
    v_mfma_f32_16x16x32_bf16 v[112:115], a[208:211], v[192:195], v[112:115]
    v_exp_f32 v172, v172
    v_mfma_f32_16x16x32_bf16 v[116:119], a[212:215], v[192:195], v[116:119]
    s_cmp_lt_u32 s28, 7
    v_fma_f32 v174, v174, s24, -v212
    v_mfma_f32_16x16x32_bf16 v[120:123], a[216:219], v[192:195], v[120:123]
    v_exp_f32 v173, v173
    v_mfma_f32_16x16x32_bf16 v[124:127], a[220:223], v[192:195], v[124:127]
    v_fma_f32 v175, v175, s24, -v212
    s_cbranch_scc1 L_loop_n4
    v_mfma_f32_16x16x32_bf16 v[160:163], a[160:163], a[0:3], 0
    v_exp_f32 v174, v174
    v_mfma_f32_16x16x32_bf16 v[160:163], a[164:167], a[4:7], v[160:163]
    v_cvt_pk_bf16_f32 v202, v172, v173
    v_mfma_f32_16x16x32_bf16 v[160:163], a[168:171], a[8:11], v[160:163]
    v_exp_f32 v175, v175
    v_mfma_f32_16x16x32_bf16 v[160:163], a[172:175], a[12:15], v[160:163]
    v_mfma_f32_16x16x32_bf16 v[160:163], a[176:179], a[16:19], v[160:163]
    s_waitcnt lgkmcnt(0)
    v_cvt_pk_bf16_f32 v203, v174, v175
    v_mfma_f32_16x16x32_bf16 v[160:163], a[180:183], a[20:23], v[160:163]
    ds_write_b64 v226, v[202:203] offset:3072
    v_add_f32 v207, v207, v172
    v_mfma_f32_16x16x32_bf16 v[160:163], a[184:187], a[24:27], v[160:163]
    v_add_f32 v207, v207, v173
    v_mfma_f32_16x16x32_bf16 v[160:163], a[188:191], a[28:31], v[160:163]
    v_add_f32 v207, v207, v174
    v_mfma_f32_16x16x32_bf16 v[164:167], a[160:163], a[32:35], 0
    s_waitcnt vmcnt(16)
    v_add_f32 v207, v207, v175
    v_mfma_f32_16x16x32_bf16 v[164:167], a[164:167], a[36:39], v[164:167]
    s_barrier
    v_mfma_f32_16x16x32_bf16 v[164:167], a[168:171], a[40:43], v[164:167]
    ds_read_b64_tr_b16 a[192:193], v218 offset:32768
    v_fma_f32 v160, v160, s24, -v209
    v_mfma_f32_16x16x32_bf16 v[164:167], a[172:175], a[44:47], v[164:167]
    ds_read_b64_tr_b16 a[194:195], v218 offset:40960
    v_fma_f32 v161, v161, s24, -v209
    v_mfma_f32_16x16x32_bf16 v[164:167], a[176:179], a[48:51], v[164:167]
    v_exp_f32 v160, v160
    v_mfma_f32_16x16x32_bf16 v[164:167], a[180:183], a[52:55], v[164:167]
    ds_read_b64_tr_b16 a[196:197], v219 offset:32768
    v_fma_f32 v162, v162, s24, -v209
    v_mfma_f32_16x16x32_bf16 v[164:167], a[184:187], a[56:59], v[164:167]
    v_exp_f32 v161, v161
    v_mfma_f32_16x16x32_bf16 v[164:167], a[188:191], a[60:63], v[164:167]
    ds_read_b64_tr_b16 a[198:199], v219 offset:40960
    v_fma_f32 v163, v163, s24, -v209
    v_mfma_f32_16x16x32_bf16 v[168:171], a[160:163], a[64:67], 0
    v_exp_f32 v162, v162
    v_mfma_f32_16x16x32_bf16 v[168:171], a[164:167], a[68:71], v[168:171]
    ds_read_b128 v[180:183], v227 offset:0
    v_cvt_pk_bf16_f32 v200, v160, v161
    v_mfma_f32_16x16x32_bf16 v[168:171], a[168:171], a[72:75], v[168:171]
    v_exp_f32 v163, v163
    v_mfma_f32_16x16x32_bf16 v[168:171], a[172:175], a[76:79], v[168:171]
    ds_read_b64_tr_b16 a[200:201], v220 offset:32768
    v_mfma_f32_16x16x32_bf16 v[168:171], a[176:179], a[80:83], v[168:171]
    ds_read_b64_tr_b16 a[202:203], v220 offset:40960
    v_cvt_pk_bf16_f32 v201, v162, v163
    v_mfma_f32_16x16x32_bf16 v[168:171], a[180:183], a[84:87], v[168:171]
    ds_write_b64 v226, v[200:201] offset:10240
    v_add_f32 v204, v204, v160
    v_mfma_f32_16x16x32_bf16 v[168:171], a[184:187], a[88:91], v[168:171]
    ds_read_b64_tr_b16 a[204:205], v221 offset:32768
    v_add_f32 v204, v204, v161
    v_mfma_f32_16x16x32_bf16 v[168:171], a[188:191], a[92:95], v[168:171]
    ds_read_b64_tr_b16 a[206:207], v221 offset:40960
    v_add_f32 v204, v204, v162
    v_mfma_f32_16x16x32_bf16 v[172:175], a[160:163], a[96:99], 0
    ds_read_b64_tr_b16 a[208:209], v222 offset:32768
    v_add_f32 v204, v204, v163
    v_mfma_f32_16x16x32_bf16 v[172:175], a[164:167], a[100:103], v[172:175]
    ds_read_b64_tr_b16 a[210:211], v222 offset:40960
    v_mfma_f32_16x16x32_bf16 v[172:175], a[168:171], a[104:107], v[172:175]
    ds_read_b64_tr_b16 a[212:213], v223 offset:32768
    v_fma_f32 v164, v164, s24, -v210
    v_mfma_f32_16x16x32_bf16 v[172:175], a[172:175], a[108:111], v[172:175]
    ds_read_b64_tr_b16 a[214:215], v223 offset:40960
    v_fma_f32 v165, v165, s24, -v210
    v_mfma_f32_16x16x32_bf16 v[172:175], a[176:179], a[112:115], v[172:175]
    v_exp_f32 v164, v164
    v_mfma_f32_16x16x32_bf16 v[172:175], a[180:183], a[116:119], v[172:175]
    ds_read_b64_tr_b16 a[216:217], v224 offset:32768
    v_fma_f32 v166, v166, s24, -v210
    v_mfma_f32_16x16x32_bf16 v[172:175], a[184:187], a[120:123], v[172:175]
    v_exp_f32 v165, v165
    v_mfma_f32_16x16x32_bf16 v[172:175], a[188:191], a[124:127], v[172:175]
    s_waitcnt lgkmcnt(4)
    ds_read_b64_tr_b16 a[218:219], v224 offset:40960
    v_fma_f32 v167, v167, s24, -v210
    v_mfma_f32_16x16x32_bf16 v[0:3], a[192:195], v[180:183], v[0:3]
    v_exp_f32 v166, v166
    v_mfma_f32_16x16x32_bf16 v[4:7], a[196:199], v[180:183], v[4:7]
    ds_read_b64_tr_b16 a[220:221], v225 offset:32768
    v_cvt_pk_bf16_f32 v202, v164, v165
    v_mfma_f32_16x16x32_bf16 v[8:11], a[200:203], v[180:183], v[8:11]
    v_exp_f32 v167, v167
    v_mfma_f32_16x16x32_bf16 v[12:15], a[204:207], v[180:183], v[12:15]
    s_waitcnt lgkmcnt(3)
    ds_read_b64_tr_b16 a[222:223], v225 offset:40960
    v_mfma_f32_16x16x32_bf16 v[16:19], a[208:211], v[180:183], v[16:19]
    ds_read_b128 v[184:187], v227 offset:1024
    v_cvt_pk_bf16_f32 v203, v166, v167
    v_mfma_f32_16x16x32_bf16 v[20:23], a[212:215], v[180:183], v[20:23]
    s_waitcnt lgkmcnt(3)
    ds_write_b64 v226, v[202:203] offset:11264
    v_add_f32 v205, v205, v164
    v_mfma_f32_16x16x32_bf16 v[24:27], a[216:219], v[180:183], v[24:27]
    s_waitcnt lgkmcnt(2)
    ds_read_b128 v[188:191], v227 offset:2048
    v_add_f32 v205, v205, v165
    v_mfma_f32_16x16x32_bf16 v[28:31], a[220:223], v[180:183], v[28:31]
    s_barrier
    s_waitcnt lgkmcnt(2)
    v_add_f32 v205, v205, v166
    v_mfma_f32_16x16x32_bf16 v[32:35], a[192:195], v[184:187], v[32:35]
    v_add_f32 v205, v205, v167
    v_mfma_f32_16x16x32_bf16 v[36:39], a[196:199], v[184:187], v[36:39]
    v_mfma_f32_16x16x32_bf16 v[40:43], a[200:203], v[184:187], v[40:43]
    ds_read_b128 v[192:195], v227 offset:3072
    v_fma_f32 v168, v168, s24, -v211
    v_mfma_f32_16x16x32_bf16 v[44:47], a[204:207], v[184:187], v[44:47]
    v_fma_f32 v169, v169, s24, -v211
    v_mfma_f32_16x16x32_bf16 v[48:51], a[208:211], v[184:187], v[48:51]
    v_exp_f32 v168, v168
    v_mfma_f32_16x16x32_bf16 v[52:55], a[212:215], v[184:187], v[52:55]
    v_fma_f32 v170, v170, s24, -v211
    v_mfma_f32_16x16x32_bf16 v[56:59], a[216:219], v[184:187], v[56:59]
    v_exp_f32 v169, v169
    v_mfma_f32_16x16x32_bf16 v[60:63], a[220:223], v[184:187], v[60:63]
    s_waitcnt lgkmcnt(1)
    v_fma_f32 v171, v171, s24, -v211
    v_mfma_f32_16x16x32_bf16 v[64:67], a[192:195], v[188:191], v[64:67]
    v_exp_f32 v170, v170
    v_mfma_f32_16x16x32_bf16 v[68:71], a[196:199], v[188:191], v[68:71]
    v_cvt_pk_bf16_f32 v200, v168, v169
    v_mfma_f32_16x16x32_bf16 v[72:75], a[200:203], v[188:191], v[72:75]
    v_exp_f32 v171, v171
    v_mfma_f32_16x16x32_bf16 v[76:79], a[204:207], v[188:191], v[76:79]
    v_mfma_f32_16x16x32_bf16 v[80:83], a[208:211], v[188:191], v[80:83]
    v_cvt_pk_bf16_f32 v201, v170, v171
    v_mfma_f32_16x16x32_bf16 v[84:87], a[212:215], v[188:191], v[84:87]
    ds_write_b64 v226, v[200:201] offset:12288
    v_add_f32 v206, v206, v168
    v_mfma_f32_16x16x32_bf16 v[88:91], a[216:219], v[188:191], v[88:91]
    v_add_f32 v206, v206, v169
    v_mfma_f32_16x16x32_bf16 v[92:95], a[220:223], v[188:191], v[92:95]
    s_waitcnt lgkmcnt(1)
    v_add_f32 v206, v206, v170
    v_mfma_f32_16x16x32_bf16 v[96:99], a[192:195], v[192:195], v[96:99]
    v_add_f32 v206, v206, v171
    v_mfma_f32_16x16x32_bf16 v[100:103], a[196:199], v[192:195], v[100:103]
    v_mfma_f32_16x16x32_bf16 v[104:107], a[200:203], v[192:195], v[104:107]
    v_fma_f32 v172, v172, s24, -v212
    v_mfma_f32_16x16x32_bf16 v[108:111], a[204:207], v[192:195], v[108:111]
    v_fma_f32 v173, v173, s24, -v212
    v_mfma_f32_16x16x32_bf16 v[112:115], a[208:211], v[192:195], v[112:115]
    v_exp_f32 v172, v172
    v_mfma_f32_16x16x32_bf16 v[116:119], a[212:215], v[192:195], v[116:119]
    v_fma_f32 v174, v174, s24, -v212
    v_mfma_f32_16x16x32_bf16 v[120:123], a[216:219], v[192:195], v[120:123]
    v_exp_f32 v173, v173
    v_mfma_f32_16x16x32_bf16 v[124:127], a[220:223], v[192:195], v[124:127]
    v_fma_f32 v175, v175, s24, -v212
    v_exp_f32 v174, v174
    s_nop 0
    v_cvt_pk_bf16_f32 v202, v172, v173
    v_exp_f32 v175, v175
    s_nop 0
    v_cvt_pk_bf16_f32 v203, v174, v175
    ds_write_b64 v226, v[202:203] offset:13312
    v_add_f32 v207, v207, v172
    v_add_f32 v207, v207, v173
    v_add_f32 v207, v207, v174
    v_add_f32 v207, v207, v175
    ds_write_b32 v237, v204 offset:0
    ds_write_b32 v237, v205 offset:256
    ds_write_b32 v237, v206 offset:512
    ds_write_b32 v237, v207 offset:768
    v_add_f32 v160, v204, v205
    v_mov_b32 v161, 0x4b800000
    v_add_f32 v160, v160, v206
    v_add_f32 v160, v160, v207
    s_lshl_b32 s35, s30, 2
    s_add_u32 s35, s35, 156672
    v_cmp_nle_f32 vcc, v160, v161
    v_mov_b32 v163, s35
    s_nop 2
    s_cmp_lg_u64 vcc, 0
    s_cselect_b32 s34, 1, 0
    v_mov_b32 v162, s34
    ds_write_b32 v163, v162
    s_waitcnt vmcnt(0) lgkmcnt(0)
    s_barrier
    ds_read_b64_tr_b16 a[192:193], v218 offset:49152
    ds_read_b64_tr_b16 a[194:195], v218 offset:57344
    ds_read_b64_tr_b16 a[196:197], v219 offset:49152
    ds_read_b64_tr_b16 a[198:199], v219 offset:57344
    ds_read_b128 v[180:183], v227 offset:10240
    ds_read_b64_tr_b16 a[200:201], v220 offset:49152
    ds_read_b64_tr_b16 a[202:203], v220 offset:57344
    ds_read_b64_tr_b16 a[204:205], v221 offset:49152
    ds_read_b64_tr_b16 a[206:207], v221 offset:57344
    ds_read_b64_tr_b16 a[208:209], v222 offset:49152
    ds_read_b64_tr_b16 a[210:211], v222 offset:57344
    ds_read_b64_tr_b16 a[212:213], v223 offset:49152
    ds_read_b64_tr_b16 a[214:215], v223 offset:57344
    ds_read_b64_tr_b16 a[216:217], v224 offset:49152
    ds_read_b64_tr_b16 a[218:219], v224 offset:57344
    ds_read_b64_tr_b16 a[220:221], v225 offset:49152
    ds_read_b64_tr_b16 a[222:223], v225 offset:57344
    v_mov_b32 v163, 156672
    ds_read_b128 v[160:163], v163
    ds_read_b32 v251, v248 offset:0
    ds_read_b32 v252, v248 offset:256
    ds_read_b32 v253, v248 offset:512
    ds_read_b32 v254, v248 offset:768
    ds_read_b128 v[184:187], v227 offset:11264
    ds_read_b128 v[188:191], v227 offset:12288
    ds_read_b128 v[192:195], v227 offset:13312
    v_and_b32 v216, 15, v236
    v_lshrrev_b32 v217, 4, v236
    s_lshl_b32 s36, s30, 14
    v_mul_u32_u24 v214, 272, v216
    v_and_b32 v215, 1, v217
    v_lshl_add_u32 v214, v215, 5, v214
    v_lshrrev_b32 v215, 1, v217
    v_lshl_add_u32 v214, v215, 4, v214
    v_add_u32 v214, s36, v214
    v_mul_u32_u24 v215, 272, v217
    v_lshl_add_u32 v215, v216, 4, v215
    v_add_u32 v215, s36, v215
    s_waitcnt lgkmcnt(15)
    v_mfma_f32_16x16x32_bf16 v[0:3], a[192:195], v[180:183], v[0:3]
    v_mfma_f32_16x16x32_bf16 v[4:7], a[196:199], v[180:183], v[4:7]
    s_waitcnt lgkmcnt(15)
    v_mfma_f32_16x16x32_bf16 v[8:11], a[200:203], v[180:183], v[8:11]
    s_waitcnt lgkmcnt(15)
    v_mfma_f32_16x16x32_bf16 v[12:15], a[204:207], v[180:183], v[12:15]
    s_waitcnt lgkmcnt(14)
    v_mfma_f32_16x16x32_bf16 v[16:19], a[208:211], v[180:183], v[16:19]
    s_waitcnt lgkmcnt(3)
    v_or_b32 v160, v160, v161
    v_add_f32 v204, v204, v251
    v_add_f32 v205, v205, v252
    v_add_f32 v206, v206, v253
    v_add_f32 v207, v207, v254
    v_or3_b32 v160, v160, v162, v163
    s_nop 0
    v_readfirstlane_b32 s34, v160
    v_mov_b32 v251, v204
    v_mov_b32 v252, v205
    s_waitcnt lgkmcnt(12)
    v_mfma_f32_16x16x32_bf16 v[20:23], a[212:215], v[180:183], v[20:23]
    v_mov_b32 v253, v206
    v_mov_b32 v254, v207
    s_nop 0
    v_permlane32_swap_b32 v251, v204
    v_permlane32_swap_b32 v252, v205
    v_permlane32_swap_b32 v253, v206
    v_permlane32_swap_b32 v254, v207
    v_add_f32 v204, v204, v251
    v_add_f32 v205, v205, v252
    v_add_f32 v206, v206, v253
    v_add_f32 v207, v207, v254
    s_waitcnt lgkmcnt(10)
    v_mfma_f32_16x16x32_bf16 v[24:27], a[216:219], v[180:183], v[24:27]
    v_mov_b32 v251, v204
    v_mov_b32 v252, v205
    v_mov_b32 v253, v206
    v_mov_b32 v254, v207
    s_nop 0
    v_permlane16_swap_b32 v251, v204
    v_permlane16_swap_b32 v252, v205
    v_permlane16_swap_b32 v253, v206
    v_permlane16_swap_b32 v254, v207
    v_add_f32 v204, v204, v251
    v_add_f32 v205, v205, v252
    s_waitcnt lgkmcnt(8)
    v_mfma_f32_16x16x32_bf16 v[28:31], a[220:223], v[180:183], v[28:31]
    v_add_f32 v206, v206, v253
    v_add_f32 v207, v207, v254
    s_andn2_b32 s34, s34, s29
    s_cmp_lg_u32 s34, 0
    s_cbranch_scc1 L_fallback_n4
    v_rcp_f32 v238, v204
    v_rcp_f32 v240, v205
    v_rcp_f32 v242, v206
    v_rcp_f32 v244, v207
    s_waitcnt lgkmcnt(0)
    v_mfma_f32_16x16x32_bf16 v[32:35], a[192:195], v[184:187], v[32:35]
    v_mfma_f32_16x16x32_bf16 v[36:39], a[196:199], v[184:187], v[36:39]
    v_mfma_f32_16x16x32_bf16 v[40:43], a[200:203], v[184:187], v[40:43]
    v_pk_mul_f32 v[0:1], v[0:1], v[238:239] op_sel_hi:[1,0]
    v_pk_mul_f32 v[2:3], v[2:3], v[238:239] op_sel_hi:[1,0]
    v_pk_mul_f32 v[4:5], v[4:5], v[238:239] op_sel_hi:[1,0]
    v_pk_mul_f32 v[6:7], v[6:7], v[238:239] op_sel_hi:[1,0]
    v_cvt_pk_bf16_f32 v200, v0, v1
    v_cvt_pk_bf16_f32 v201, v2, v3
    v_cvt_pk_bf16_f32 v202, v4, v5
    v_cvt_pk_bf16_f32 v203, v6, v7
    v_mfma_f32_16x16x32_bf16 v[44:47], a[204:207], v[184:187], v[44:47]
    v_pk_mul_f32 v[8:9], v[8:9], v[238:239] op_sel_hi:[1,0]
    v_pk_mul_f32 v[10:11], v[10:11], v[238:239] op_sel_hi:[1,0]
    v_pk_mul_f32 v[12:13], v[12:13], v[238:239] op_sel_hi:[1,0]
    v_pk_mul_f32 v[14:15], v[14:15], v[238:239] op_sel_hi:[1,0]
    v_permlane16_swap_b32 v200, v202
    v_permlane16_swap_b32 v201, v203
    ds_write_b128 v214, v[200:203] offset:0
    v_cvt_pk_bf16_f32 v228, v8, v9
    v_mfma_f32_16x16x32_bf16 v[48:51], a[208:211], v[184:187], v[48:51]
    v_cvt_pk_bf16_f32 v229, v10, v11
    v_cvt_pk_bf16_f32 v230, v12, v13
    v_cvt_pk_bf16_f32 v231, v14, v15
    v_pk_mul_f32 v[16:17], v[16:17], v[238:239] op_sel_hi:[1,0]
    v_pk_mul_f32 v[18:19], v[18:19], v[238:239] op_sel_hi:[1,0]
    v_pk_mul_f32 v[20:21], v[20:21], v[238:239] op_sel_hi:[1,0]
    v_pk_mul_f32 v[22:23], v[22:23], v[238:239] op_sel_hi:[1,0]
    v_permlane16_swap_b32 v228, v230
    v_mfma_f32_16x16x32_bf16 v[52:55], a[212:215], v[184:187], v[52:55]
    v_permlane16_swap_b32 v229, v231
    ds_write_b128 v214, v[228:231] offset:64
    v_cvt_pk_bf16_f32 v232, v16, v17
    v_cvt_pk_bf16_f32 v233, v18, v19
    v_cvt_pk_bf16_f32 v234, v20, v21
    v_cvt_pk_bf16_f32 v235, v22, v23
    v_pk_mul_f32 v[24:25], v[24:25], v[238:239] op_sel_hi:[1,0]
    v_mfma_f32_16x16x32_bf16 v[56:59], a[216:219], v[184:187], v[56:59]
    v_pk_mul_f32 v[26:27], v[26:27], v[238:239] op_sel_hi:[1,0]
    v_pk_mul_f32 v[28:29], v[28:29], v[238:239] op_sel_hi:[1,0]
    v_pk_mul_f32 v[30:31], v[30:31], v[238:239] op_sel_hi:[1,0]
    v_permlane16_swap_b32 v232, v234
    v_permlane16_swap_b32 v233, v235
    ds_write_b128 v214, v[232:235] offset:128
    v_cvt_pk_bf16_f32 v200, v24, v25
    v_mfma_f32_16x16x32_bf16 v[60:63], a[220:223], v[184:187], v[60:63]
    v_cvt_pk_bf16_f32 v201, v26, v27
    v_cvt_pk_bf16_f32 v202, v28, v29
    v_cvt_pk_bf16_f32 v203, v30, v31
    s_nop 1
    v_permlane16_swap_b32 v200, v202
    v_permlane16_swap_b32 v201, v203
    ds_write_b128 v214, v[200:203] offset:192
    v_mfma_f32_16x16x32_bf16 v[64:67], a[192:195], v[188:191], v[64:67]
    v_mfma_f32_16x16x32_bf16 v[68:71], a[196:199], v[188:191], v[68:71]
    v_mfma_f32_16x16x32_bf16 v[72:75], a[200:203], v[188:191], v[72:75]
    ds_read_b128 v[160:163], v215 offset:0
    ds_read_b128 v[164:167], v215 offset:1088
    ds_read_b128 v[168:171], v215 offset:2176
    ds_read_b128 v[172:175], v215 offset:3264
    v_pk_mul_f32 v[32:33], v[32:33], v[240:241] op_sel_hi:[1,0]
    v_pk_mul_f32 v[34:35], v[34:35], v[240:241] op_sel_hi:[1,0]
    v_pk_mul_f32 v[36:37], v[36:37], v[240:241] op_sel_hi:[1,0]
    v_pk_mul_f32 v[38:39], v[38:39], v[240:241] op_sel_hi:[1,0]
    v_cvt_pk_bf16_f32 v228, v32, v33
    v_mfma_f32_16x16x32_bf16 v[76:79], a[204:207], v[188:191], v[76:79]
    v_cvt_pk_bf16_f32 v229, v34, v35
    v_cvt_pk_bf16_f32 v230, v36, v37
    v_cvt_pk_bf16_f32 v231, v38, v39
    v_pk_mul_f32 v[40:41], v[40:41], v[240:241] op_sel_hi:[1,0]
    v_pk_mul_f32 v[42:43], v[42:43], v[240:241] op_sel_hi:[1,0]
    v_pk_mul_f32 v[44:45], v[44:45], v[240:241] op_sel_hi:[1,0]
    v_pk_mul_f32 v[46:47], v[46:47], v[240:241] op_sel_hi:[1,0]
    v_permlane16_swap_b32 v228, v230
    v_permlane16_swap_b32 v229, v231
    v_mfma_f32_16x16x32_bf16 v[80:83], a[208:211], v[188:191], v[80:83]
    ds_write_b128 v214, v[228:231] offset:4352
    s_waitcnt lgkmcnt(1)
    buffer_store_dwordx4 v[160:163], v249, s[20:23], s44 offen offset:0 nt
    v_cvt_pk_bf16_f32 v232, v40, v41
    v_cvt_pk_bf16_f32 v233, v42, v43
    v_cvt_pk_bf16_f32 v234, v44, v45
    v_cvt_pk_bf16_f32 v235, v46, v47
    v_pk_mul_f32 v[48:49], v[48:49], v[240:241] op_sel_hi:[1,0]
    v_pk_mul_f32 v[50:51], v[50:51], v[240:241] op_sel_hi:[1,0]
    v_mfma_f32_16x16x32_bf16 v[84:87], a[212:215], v[188:191], v[84:87]
    v_pk_mul_f32 v[52:53], v[52:53], v[240:241] op_sel_hi:[1,0]
    v_pk_mul_f32 v[54:55], v[54:55], v[240:241] op_sel_hi:[1,0]
    v_permlane16_swap_b32 v232, v234
    v_permlane16_swap_b32 v233, v235
    ds_write_b128 v214, v[232:235] offset:4416
    buffer_store_dwordx4 v[164:167], v249, s[20:23], s44 offen offset:2048 nt
    v_cvt_pk_bf16_f32 v200, v48, v49
    v_cvt_pk_bf16_f32 v201, v50, v51
    v_cvt_pk_bf16_f32 v202, v52, v53
    v_mfma_f32_16x16x32_bf16 v[88:91], a[216:219], v[188:191], v[88:91]
    v_cvt_pk_bf16_f32 v203, v54, v55
    v_pk_mul_f32 v[56:57], v[56:57], v[240:241] op_sel_hi:[1,0]
    v_pk_mul_f32 v[58:59], v[58:59], v[240:241] op_sel_hi:[1,0]
    v_pk_mul_f32 v[60:61], v[60:61], v[240:241] op_sel_hi:[1,0]
    v_pk_mul_f32 v[62:63], v[62:63], v[240:241] op_sel_hi:[1,0]
    v_permlane16_swap_b32 v200, v202
    v_permlane16_swap_b32 v201, v203
    ds_write_b128 v214, v[200:203] offset:4480
    buffer_store_dwordx4 v[168:171], v250, s[20:23], s44 offen offset:0 nt
    v_mfma_f32_16x16x32_bf16 v[92:95], a[220:223], v[188:191], v[92:95]
    v_cvt_pk_bf16_f32 v228, v56, v57
    v_cvt_pk_bf16_f32 v229, v58, v59
    v_cvt_pk_bf16_f32 v230, v60, v61
    v_cvt_pk_bf16_f32 v231, v62, v63
    s_nop 1
    v_permlane16_swap_b32 v228, v230
    v_permlane16_swap_b32 v229, v231
    ds_write_b128 v214, v[228:231] offset:4544
    buffer_store_dwordx4 v[172:175], v250, s[20:23], s44 offen offset:2048 nt
    v_mfma_f32_16x16x32_bf16 v[96:99], a[192:195], v[192:195], v[96:99]
    v_mfma_f32_16x16x32_bf16 v[100:103], a[196:199], v[192:195], v[100:103]
    v_mfma_f32_16x16x32_bf16 v[104:107], a[200:203], v[192:195], v[104:107]
    ds_read_b128 v[160:163], v215 offset:4352
    ds_read_b128 v[164:167], v215 offset:5440
    ds_read_b128 v[168:171], v215 offset:6528
    ds_read_b128 v[172:175], v215 offset:7616
    v_pk_mul_f32 v[64:65], v[64:65], v[242:243] op_sel_hi:[1,0]
    v_pk_mul_f32 v[66:67], v[66:67], v[242:243] op_sel_hi:[1,0]
    v_pk_mul_f32 v[68:69], v[68:69], v[242:243] op_sel_hi:[1,0]
    v_pk_mul_f32 v[70:71], v[70:71], v[242:243] op_sel_hi:[1,0]
    v_cvt_pk_bf16_f32 v232, v64, v65
    v_mfma_f32_16x16x32_bf16 v[108:111], a[204:207], v[192:195], v[108:111]
    v_cvt_pk_bf16_f32 v233, v66, v67
    v_cvt_pk_bf16_f32 v234, v68, v69
    v_cvt_pk_bf16_f32 v235, v70, v71
    v_pk_mul_f32 v[72:73], v[72:73], v[242:243] op_sel_hi:[1,0]
    v_pk_mul_f32 v[74:75], v[74:75], v[242:243] op_sel_hi:[1,0]
    v_pk_mul_f32 v[76:77], v[76:77], v[242:243] op_sel_hi:[1,0]
    v_pk_mul_f32 v[78:79], v[78:79], v[242:243] op_sel_hi:[1,0]
    v_permlane16_swap_b32 v232, v234
    v_permlane16_swap_b32 v233, v235
    v_mfma_f32_16x16x32_bf16 v[112:115], a[208:211], v[192:195], v[112:115]
    ds_write_b128 v214, v[232:235] offset:8704
    s_waitcnt lgkmcnt(1)
    buffer_store_dwordx4 v[160:163], v249, s[20:23], s45 offen offset:0 nt
    v_cvt_pk_bf16_f32 v200, v72, v73
    v_cvt_pk_bf16_f32 v201, v74, v75
    v_cvt_pk_bf16_f32 v202, v76, v77
    v_cvt_pk_bf16_f32 v203, v78, v79
    v_pk_mul_f32 v[80:81], v[80:81], v[242:243] op_sel_hi:[1,0]
    v_pk_mul_f32 v[82:83], v[82:83], v[242:243] op_sel_hi:[1,0]
    v_mfma_f32_16x16x32_bf16 v[116:119], a[212:215], v[192:195], v[116:119]
    v_pk_mul_f32 v[84:85], v[84:85], v[242:243] op_sel_hi:[1,0]
    v_pk_mul_f32 v[86:87], v[86:87], v[242:243] op_sel_hi:[1,0]
    v_permlane16_swap_b32 v200, v202
    v_permlane16_swap_b32 v201, v203
    ds_write_b128 v214, v[200:203] offset:8768
    buffer_store_dwordx4 v[164:167], v249, s[20:23], s45 offen offset:2048 nt
    v_cvt_pk_bf16_f32 v228, v80, v81
    v_cvt_pk_bf16_f32 v229, v82, v83
    v_cvt_pk_bf16_f32 v230, v84, v85
    v_mfma_f32_16x16x32_bf16 v[120:123], a[216:219], v[192:195], v[120:123]
    v_cvt_pk_bf16_f32 v231, v86, v87
    v_pk_mul_f32 v[88:89], v[88:89], v[242:243] op_sel_hi:[1,0]
    v_pk_mul_f32 v[90:91], v[90:91], v[242:243] op_sel_hi:[1,0]
    v_pk_mul_f32 v[92:93], v[92:93], v[242:243] op_sel_hi:[1,0]
    v_pk_mul_f32 v[94:95], v[94:95], v[242:243] op_sel_hi:[1,0]
    v_permlane16_swap_b32 v228, v230
    v_permlane16_swap_b32 v229, v231
    ds_write_b128 v214, v[228:231] offset:8832
    buffer_store_dwordx4 v[168:171], v250, s[20:23], s45 offen offset:0 nt
    v_mfma_f32_16x16x32_bf16 v[124:127], a[220:223], v[192:195], v[124:127]
    v_cvt_pk_bf16_f32 v232, v88, v89
    v_cvt_pk_bf16_f32 v233, v90, v91
    v_cvt_pk_bf16_f32 v234, v92, v93
    v_cvt_pk_bf16_f32 v235, v94, v95
    s_nop 1
    v_permlane16_swap_b32 v232, v234
    v_permlane16_swap_b32 v233, v235
    ds_write_b128 v214, v[232:235] offset:8896
    buffer_store_dwordx4 v[172:175], v250, s[20:23], s45 offen offset:2048 nt
    s_nop 7
    ds_read_b128 v[160:163], v215 offset:8704
    ds_read_b128 v[164:167], v215 offset:9792
    ds_read_b128 v[168:171], v215 offset:10880
    ds_read_b128 v[172:175], v215 offset:11968
    v_pk_mul_f32 v[96:97], v[96:97], v[244:245] op_sel_hi:[1,0]
    v_pk_mul_f32 v[98:99], v[98:99], v[244:245] op_sel_hi:[1,0]
    v_pk_mul_f32 v[100:101], v[100:101], v[244:245] op_sel_hi:[1,0]
    v_pk_mul_f32 v[102:103], v[102:103], v[244:245] op_sel_hi:[1,0]
    v_cvt_pk_bf16_f32 v200, v96, v97
    v_cvt_pk_bf16_f32 v201, v98, v99
    v_cvt_pk_bf16_f32 v202, v100, v101
    v_cvt_pk_bf16_f32 v203, v102, v103
    v_pk_mul_f32 v[104:105], v[104:105], v[244:245] op_sel_hi:[1,0]
    v_pk_mul_f32 v[106:107], v[106:107], v[244:245] op_sel_hi:[1,0]
    v_pk_mul_f32 v[108:109], v[108:109], v[244:245] op_sel_hi:[1,0]
    v_pk_mul_f32 v[110:111], v[110:111], v[244:245] op_sel_hi:[1,0]
    v_permlane16_swap_b32 v200, v202
    v_permlane16_swap_b32 v201, v203
    ds_write_b128 v214, v[200:203] offset:0
    s_waitcnt lgkmcnt(1)
    buffer_store_dwordx4 v[160:163], v249, s[20:23], s46 offen offset:0 nt
    v_cvt_pk_bf16_f32 v228, v104, v105
    v_cvt_pk_bf16_f32 v229, v106, v107
    v_cvt_pk_bf16_f32 v230, v108, v109
    v_cvt_pk_bf16_f32 v231, v110, v111
    v_pk_mul_f32 v[112:113], v[112:113], v[244:245] op_sel_hi:[1,0]
    v_pk_mul_f32 v[114:115], v[114:115], v[244:245] op_sel_hi:[1,0]
    v_pk_mul_f32 v[116:117], v[116:117], v[244:245] op_sel_hi:[1,0]
    v_pk_mul_f32 v[118:119], v[118:119], v[244:245] op_sel_hi:[1,0]
    v_permlane16_swap_b32 v228, v230
    v_permlane16_swap_b32 v229, v231
    ds_write_b128 v214, v[228:231] offset:64
    buffer_store_dwordx4 v[164:167], v249, s[20:23], s46 offen offset:2048 nt
    v_cvt_pk_bf16_f32 v232, v112, v113
    v_cvt_pk_bf16_f32 v233, v114, v115
    v_cvt_pk_bf16_f32 v234, v116, v117
    v_cvt_pk_bf16_f32 v235, v118, v119
    v_pk_mul_f32 v[120:121], v[120:121], v[244:245] op_sel_hi:[1,0]
    v_pk_mul_f32 v[122:123], v[122:123], v[244:245] op_sel_hi:[1,0]
    v_pk_mul_f32 v[124:125], v[124:125], v[244:245] op_sel_hi:[1,0]
    v_pk_mul_f32 v[126:127], v[126:127], v[244:245] op_sel_hi:[1,0]
    v_permlane16_swap_b32 v232, v234
    v_permlane16_swap_b32 v233, v235
    ds_write_b128 v214, v[232:235] offset:128
    buffer_store_dwordx4 v[168:171], v250, s[20:23], s46 offen offset:0 nt
    v_cvt_pk_bf16_f32 v200, v120, v121
    v_cvt_pk_bf16_f32 v201, v122, v123
    v_cvt_pk_bf16_f32 v202, v124, v125
    v_cvt_pk_bf16_f32 v203, v126, v127
    s_nop 1
    v_permlane16_swap_b32 v200, v202
    v_permlane16_swap_b32 v201, v203
    ds_write_b128 v214, v[200:203] offset:192
    buffer_store_dwordx4 v[172:175], v250, s[20:23], s46 offen offset:2048 nt
    ds_read_b128 v[160:163], v215 offset:0
    ds_read_b128 v[164:167], v215 offset:1088
    ds_read_b128 v[168:171], v215 offset:2176
    ds_read_b128 v[172:175], v215 offset:3264
    s_waitcnt lgkmcnt(0)
    buffer_store_dwordx4 v[160:163], v249, s[20:23], s47 offen offset:0 nt
    buffer_store_dwordx4 v[164:167], v249, s[20:23], s47 offen offset:2048 nt
    buffer_store_dwordx4 v[168:171], v250, s[20:23], s47 offen offset:0 nt
    buffer_store_dwordx4 v[172:175], v250, s[20:23], s47 offen offset:2048 nt
    s_endpgm
L_fallback_n4:
    s_waitcnt vmcnt(0) lgkmcnt(0)
    s_barrier
    v_and_b32 v251, 15, v236
    v_lshrrev_b32 v252, 4, v236
    s_lshl_b32 s34, s32, 13
    v_lshlrev_b32 v253, 9, v251
    v_add_u32 v253, s34, v253
    v_add_u32 v254, 0, v252
    v_xor_b32 v254, v254, v251
    v_lshl_add_u32 v214, v254, 4, v253
    v_add_u32 v254, 4, v252
    v_xor_b32 v254, v254, v251
    v_lshl_add_u32 v215, v254, 4, v253
    v_add_u32 v254, 8, v252
    v_xor_b32 v254, v254, v251
    v_lshl_add_u32 v216, v254, 4, v253
    v_add_u32 v254, 12, v252
    v_xor_b32 v254, v254, v251
    v_lshl_add_u32 v217, v254, 4, v253
    v_lshrrev_b32 v251, 5, v236
    v_and_b32 v252, 31, v236
    s_lshl_b32 s34, s30, 3
    v_add_u32 v254, s34, v251
    v_lshlrev_b32 v253, 9, v254
    v_add_u32 v255, 0, v254
    v_and_b32 v255, 15, v255
    v_xor_b32 v255, v255, v252
    v_lshl_add_u32 v228, v255, 4, v253
    v_add_u32 v255, 0, v251
    v_lshlrev_b32 v255, 1, v255
    v_xor_b32 v255, v255, v252
    v_lshl_add_u32 v232, v255, 4, v253
    v_add_u32 v255, 2, v254
    v_and_b32 v255, 15, v255
    v_xor_b32 v255, v255, v252
    v_lshl_add_u32 v229, v255, 4, v253
    v_add_u32 v255, 2, v251
    v_lshlrev_b32 v255, 1, v255
    v_xor_b32 v255, v255, v252
    v_lshl_add_u32 v233, v255, 4, v253
    v_add_u32 v255, 4, v254
    v_and_b32 v255, 15, v255
    v_xor_b32 v255, v255, v252
    v_lshl_add_u32 v230, v255, 4, v253
    v_add_u32 v255, 4, v251
    v_lshlrev_b32 v255, 1, v255
    v_xor_b32 v255, v255, v252
    v_lshl_add_u32 v234, v255, 4, v253
    v_add_u32 v255, 6, v254
    v_and_b32 v255, 15, v255
    v_xor_b32 v255, v255, v252
    v_lshl_add_u32 v231, v255, 4, v253
    v_add_u32 v255, 6, v251
    v_lshlrev_b32 v255, 1, v255
    v_xor_b32 v255, v255, v252
    v_lshl_add_u32 v235, v255, 4, v253
    v_mov_b32 v209, 0xff800000
    v_mov_b32 v210, 0xff800000
    v_mov_b32 v211, 0xff800000
    v_mov_b32 v212, 0xff800000
    s_mov_b32 s26, 0
    s_mov_b32 s28, 0
    s_mov_b32 s14, 524288
L_fbloop_n4:
    s_add_u32 m0, s25, 0
    s_nop 0
    buffer_load_dwordx4 v228, s[12:15], s26 offen offset:0 nt lds
    buffer_load_dwordx4 v229, s[12:15], s26 offen offset:1024 nt lds
    buffer_load_dwordx4 v230, s[12:15], s26 offen offset:2048 nt lds
    buffer_load_dwordx4 v231, s[12:15], s26 offen offset:3072 nt lds
    s_add_u32 s26, s26, 16384
    s_and_b32 s26, s26, 0x7ffff
    s_waitcnt vmcnt(0)
    s_barrier
    ds_read_b128 a[160:163], v214 offset:0
    ds_read_b128 a[164:167], v215 offset:0
    ds_read_b128 a[168:171], v216 offset:0
    ds_read_b128 a[172:175], v217 offset:0
    ds_read_b128 a[176:179], v214 offset:256
    ds_read_b128 a[180:183], v215 offset:256
    ds_read_b128 a[184:187], v216 offset:256
    ds_read_b128 a[188:191], v217 offset:256
    s_waitcnt lgkmcnt(0)
    s_barrier
    v_mfma_f32_16x16x32_bf16 v[160:163], a[160:163], a[0:3], 0
    v_mfma_f32_16x16x32_bf16 v[160:163], a[164:167], a[4:7], v[160:163]
    v_mfma_f32_16x16x32_bf16 v[160:163], a[168:171], a[8:11], v[160:163]
    v_mfma_f32_16x16x32_bf16 v[160:163], a[172:175], a[12:15], v[160:163]
    v_mfma_f32_16x16x32_bf16 v[160:163], a[176:179], a[16:19], v[160:163]
    v_mfma_f32_16x16x32_bf16 v[160:163], a[180:183], a[20:23], v[160:163]
    v_mfma_f32_16x16x32_bf16 v[160:163], a[184:187], a[24:27], v[160:163]
    v_mfma_f32_16x16x32_bf16 v[160:163], a[188:191], a[28:31], v[160:163]
    v_mfma_f32_16x16x32_bf16 v[164:167], a[160:163], a[32:35], 0
    v_mfma_f32_16x16x32_bf16 v[164:167], a[164:167], a[36:39], v[164:167]
    v_mfma_f32_16x16x32_bf16 v[164:167], a[168:171], a[40:43], v[164:167]
    v_mfma_f32_16x16x32_bf16 v[164:167], a[172:175], a[44:47], v[164:167]
    v_mfma_f32_16x16x32_bf16 v[164:167], a[176:179], a[48:51], v[164:167]
    v_mfma_f32_16x16x32_bf16 v[164:167], a[180:183], a[52:55], v[164:167]
    v_mfma_f32_16x16x32_bf16 v[164:167], a[184:187], a[56:59], v[164:167]
    v_mfma_f32_16x16x32_bf16 v[164:167], a[188:191], a[60:63], v[164:167]
    v_mfma_f32_16x16x32_bf16 v[168:171], a[160:163], a[64:67], 0
    v_mfma_f32_16x16x32_bf16 v[168:171], a[164:167], a[68:71], v[168:171]
    v_mfma_f32_16x16x32_bf16 v[168:171], a[168:171], a[72:75], v[168:171]
    v_mfma_f32_16x16x32_bf16 v[168:171], a[172:175], a[76:79], v[168:171]
    v_mfma_f32_16x16x32_bf16 v[168:171], a[176:179], a[80:83], v[168:171]
    v_mfma_f32_16x16x32_bf16 v[168:171], a[180:183], a[84:87], v[168:171]
    v_mfma_f32_16x16x32_bf16 v[168:171], a[184:187], a[88:91], v[168:171]
    v_mfma_f32_16x16x32_bf16 v[168:171], a[188:191], a[92:95], v[168:171]
    v_mfma_f32_16x16x32_bf16 v[172:175], a[160:163], a[96:99], 0
    v_mfma_f32_16x16x32_bf16 v[172:175], a[164:167], a[100:103], v[172:175]
    v_mfma_f32_16x16x32_bf16 v[172:175], a[168:171], a[104:107], v[172:175]
    v_mfma_f32_16x16x32_bf16 v[172:175], a[172:175], a[108:111], v[172:175]
    v_mfma_f32_16x16x32_bf16 v[172:175], a[176:179], a[112:115], v[172:175]
    v_mfma_f32_16x16x32_bf16 v[172:175], a[180:183], a[116:119], v[172:175]
    v_mfma_f32_16x16x32_bf16 v[172:175], a[184:187], a[120:123], v[172:175]
    v_mfma_f32_16x16x32_bf16 v[172:175], a[188:191], a[124:127], v[172:175]
    s_nop 7
    v_max3_f32 v209, v209, v160, v161
    v_max3_f32 v209, v209, v162, v163
    v_max3_f32 v210, v210, v164, v165
    v_max3_f32 v210, v210, v166, v167
    v_max3_f32 v211, v211, v168, v169
    v_max3_f32 v211, v211, v170, v171
    v_max3_f32 v212, v212, v172, v173
    v_max3_f32 v212, v212, v174, v175
    s_add_u32 s28, s28, 1
    s_cmp_lt_u32 s28, 32
    s_cbranch_scc1 L_fbloop_n4
    v_mov_b32 v251, v209
    v_mov_b32 v252, v210
    v_mov_b32 v253, v211
    v_mov_b32 v254, v212
    s_nop 0
    v_permlane32_swap_b32 v251, v209
    v_permlane32_swap_b32 v252, v210
    v_permlane32_swap_b32 v253, v211
    v_permlane32_swap_b32 v254, v212
    v_max_f32 v209, v209, v251
    v_max_f32 v210, v210, v252
    v_max_f32 v211, v211, v253
    v_max_f32 v212, v212, v254
    v_mov_b32 v251, v209
    v_mov_b32 v252, v210
    v_mov_b32 v253, v211
    v_mov_b32 v254, v212
    s_nop 0
    v_permlane16_swap_b32 v251, v209
    v_permlane16_swap_b32 v252, v210
    v_permlane16_swap_b32 v253, v211
    v_permlane16_swap_b32 v254, v212
    v_max_f32 v209, v209, v251
    v_max_f32 v210, v210, v252
    v_max_f32 v211, v211, v253
    v_max_f32 v212, v212, v254
    ds_write_b32 v237, v209 offset:0
    ds_write_b32 v237, v210 offset:256
    ds_write_b32 v237, v211 offset:512
    ds_write_b32 v237, v212 offset:768
    s_waitcnt lgkmcnt(0)
    s_barrier
    ds_read_b32 v251, v248 offset:0
    ds_read_b32 v252, v248 offset:256
    ds_read_b32 v253, v248 offset:512
    ds_read_b32 v254, v248 offset:768
    s_waitcnt lgkmcnt(0)
    v_max_f32 v209, v209, v251
    v_max_f32 v210, v210, v252
    v_max_f32 v211, v211, v253
    v_max_f32 v212, v212, v254
    v_mul_f32 v209, s24, v209
    v_mul_f32 v210, s24, v210
    v_mul_f32 v211, s24, v211
    v_mul_f32 v212, s24, v212
    s_mov_b32 s29, 1
    s_barrier
    s_mov_b32 s26, s42
    s_mov_b32 s27, s42
    s_mov_b32 s14, 524288
    s_mov_b32 s18, 524288
    s_add_u32 m0, s25, 0
    s_nop 0
    buffer_load_dwordx4 v228, s[12:15], s26 offen offset:0 nt lds
    buffer_load_dwordx4 v229, s[12:15], s26 offen offset:1024 nt lds
    buffer_load_dwordx4 v230, s[12:15], s26 offen offset:2048 nt lds
    buffer_load_dwordx4 v231, s[12:15], s26 offen offset:3072 nt lds
    s_add_u32 s26, s26, 16384
    s_and_b32 s26, s26, 0x7ffff
    v_mov_b32 v0, 0
    v_mov_b32 v1, 0
    v_mov_b32 v2, 0
    v_mov_b32 v3, 0
    v_mov_b32 v4, 0
    v_mov_b32 v5, 0
    v_mov_b32 v6, 0
    v_mov_b32 v7, 0
    v_mov_b32 v8, 0
    v_mov_b32 v9, 0
    v_mov_b32 v10, 0
    v_mov_b32 v11, 0
    v_mov_b32 v12, 0
    v_mov_b32 v13, 0
    v_mov_b32 v14, 0
    v_mov_b32 v15, 0
    v_mov_b32 v16, 0
    v_mov_b32 v17, 0
    v_mov_b32 v18, 0
    v_mov_b32 v19, 0
    v_mov_b32 v20, 0
    v_mov_b32 v21, 0
    v_mov_b32 v22, 0
    v_mov_b32 v23, 0
    v_mov_b32 v24, 0
    v_mov_b32 v25, 0
    v_mov_b32 v26, 0
    v_mov_b32 v27, 0
    v_mov_b32 v28, 0
    v_mov_b32 v29, 0
    v_mov_b32 v30, 0
    v_mov_b32 v31, 0
    v_mov_b32 v32, 0
    v_mov_b32 v33, 0
    v_mov_b32 v34, 0
    v_mov_b32 v35, 0
    v_mov_b32 v36, 0
    v_mov_b32 v37, 0
    v_mov_b32 v38, 0
    v_mov_b32 v39, 0
    v_mov_b32 v40, 0
    v_mov_b32 v41, 0
    v_mov_b32 v42, 0
    v_mov_b32 v43, 0
    v_mov_b32 v44, 0
    v_mov_b32 v45, 0
    v_mov_b32 v46, 0
    v_mov_b32 v47, 0
    v_mov_b32 v48, 0
    v_mov_b32 v49, 0
    v_mov_b32 v50, 0
    v_mov_b32 v51, 0
    v_mov_b32 v52, 0
    v_mov_b32 v53, 0
    v_mov_b32 v54, 0
    v_mov_b32 v55, 0
    v_mov_b32 v56, 0
    v_mov_b32 v57, 0
    v_mov_b32 v58, 0
    v_mov_b32 v59, 0
    v_mov_b32 v60, 0
    v_mov_b32 v61, 0
    v_mov_b32 v62, 0
    v_mov_b32 v63, 0
    v_mov_b32 v64, 0
    v_mov_b32 v65, 0
    v_mov_b32 v66, 0
    v_mov_b32 v67, 0
    v_mov_b32 v68, 0
    v_mov_b32 v69, 0
    v_mov_b32 v70, 0
    v_mov_b32 v71, 0
    v_mov_b32 v72, 0
    v_mov_b32 v73, 0
    v_mov_b32 v74, 0
    v_mov_b32 v75, 0
    v_mov_b32 v76, 0
    v_mov_b32 v77, 0
    v_mov_b32 v78, 0
    v_mov_b32 v79, 0
    v_mov_b32 v80, 0
    v_mov_b32 v81, 0
    v_mov_b32 v82, 0
    v_mov_b32 v83, 0
    v_mov_b32 v84, 0
    v_mov_b32 v85, 0
    v_mov_b32 v86, 0
    v_mov_b32 v87, 0
    v_mov_b32 v88, 0
    v_mov_b32 v89, 0
    v_mov_b32 v90, 0
    v_mov_b32 v91, 0
    v_mov_b32 v92, 0
    v_mov_b32 v93, 0
    v_mov_b32 v94, 0
    v_mov_b32 v95, 0
    v_mov_b32 v96, 0
    v_mov_b32 v97, 0
    v_mov_b32 v98, 0
    v_mov_b32 v99, 0
    v_mov_b32 v100, 0
    v_mov_b32 v101, 0
    v_mov_b32 v102, 0
    v_mov_b32 v103, 0
    v_mov_b32 v104, 0
    v_mov_b32 v105, 0
    v_mov_b32 v106, 0
    v_mov_b32 v107, 0
    v_mov_b32 v108, 0
    v_mov_b32 v109, 0
    v_mov_b32 v110, 0
    v_mov_b32 v111, 0
    v_mov_b32 v112, 0
    v_mov_b32 v113, 0
    v_mov_b32 v114, 0
    v_mov_b32 v115, 0
    v_mov_b32 v116, 0
    v_mov_b32 v117, 0
    v_mov_b32 v118, 0
    v_mov_b32 v119, 0
    v_mov_b32 v120, 0
    v_mov_b32 v121, 0
    v_mov_b32 v122, 0
    v_mov_b32 v123, 0
    v_mov_b32 v124, 0
    v_mov_b32 v125, 0
    v_mov_b32 v126, 0
    v_mov_b32 v127, 0
    v_mov_b32 v204, 0
    v_mov_b32 v205, 0
    v_mov_b32 v206, 0
    v_mov_b32 v207, 0
    s_waitcnt vmcnt(0)
    s_barrier
    ds_read_b128 a[160:163], v214 offset:0
    ds_read_b128 a[164:167], v215 offset:0
    ds_read_b128 a[168:171], v216 offset:0
    ds_read_b128 a[172:175], v217 offset:0
    ds_read_b128 a[176:179], v214 offset:256
    ds_read_b128 a[180:183], v215 offset:256
    ds_read_b128 a[184:187], v216 offset:256
    ds_read_b128 a[188:191], v217 offset:256
    s_add_u32 m0, s25, 16384
    s_nop 0
    buffer_load_dwordx4 v228, s[12:15], s26 offen offset:0 nt lds
    buffer_load_dwordx4 v229, s[12:15], s26 offen offset:1024 nt lds
    buffer_load_dwordx4 v230, s[12:15], s26 offen offset:2048 nt lds
    buffer_load_dwordx4 v231, s[12:15], s26 offen offset:3072 nt lds
    s_add_u32 s26, s26, 16384
    s_and_b32 s26, s26, 0x7ffff
    s_add_u32 m0, s25, 65536
    s_nop 0
    buffer_load_dwordx4 v232, s[16:19], s27 offen offset:0 nt lds
    buffer_load_dwordx4 v233, s[16:19], s27 offen offset:1024 nt lds
    buffer_load_dwordx4 v234, s[16:19], s27 offen offset:2048 nt lds
    buffer_load_dwordx4 v235, s[16:19], s27 offen offset:3072 nt lds
    s_add_u32 s27, s27, 16384
    s_and_b32 s27, s27, 0x7ffff
    s_add_u32 m0, s25, 32768
    s_nop 0
    buffer_load_dwordx4 v228, s[12:15], s26 offen offset:0 nt lds
    buffer_load_dwordx4 v229, s[12:15], s26 offen offset:1024 nt lds
    buffer_load_dwordx4 v230, s[12:15], s26 offen offset:2048 nt lds
    buffer_load_dwordx4 v231, s[12:15], s26 offen offset:3072 nt lds
    s_add_u32 s26, s26, 16384
    s_and_b32 s26, s26, 0x7ffff
    s_add_u32 m0, s25, 81920
    s_nop 0
    buffer_load_dwordx4 v232, s[16:19], s27 offen offset:0 nt lds
    buffer_load_dwordx4 v233, s[16:19], s27 offen offset:1024 nt lds
    buffer_load_dwordx4 v234, s[16:19], s27 offen offset:2048 nt lds
    buffer_load_dwordx4 v235, s[16:19], s27 offen offset:3072 nt lds
    s_add_u32 s27, s27, 16384
    s_and_b32 s27, s27, 0x7ffff
    s_waitcnt lgkmcnt(0)
    v_mfma_f32_16x16x32_bf16 v[160:163], a[160:163], a[0:3], 0
    v_mfma_f32_16x16x32_bf16 v[160:163], a[164:167], a[4:7], v[160:163]
    v_mfma_f32_16x16x32_bf16 v[160:163], a[168:171], a[8:11], v[160:163]
    v_mfma_f32_16x16x32_bf16 v[160:163], a[172:175], a[12:15], v[160:163]
    v_mfma_f32_16x16x32_bf16 v[160:163], a[176:179], a[16:19], v[160:163]
    v_mfma_f32_16x16x32_bf16 v[160:163], a[180:183], a[20:23], v[160:163]
    v_mfma_f32_16x16x32_bf16 v[160:163], a[184:187], a[24:27], v[160:163]
    v_mfma_f32_16x16x32_bf16 v[160:163], a[188:191], a[28:31], v[160:163]
    v_mfma_f32_16x16x32_bf16 v[164:167], a[160:163], a[32:35], 0
    v_mfma_f32_16x16x32_bf16 v[164:167], a[164:167], a[36:39], v[164:167]
    v_mfma_f32_16x16x32_bf16 v[164:167], a[168:171], a[40:43], v[164:167]
    v_mfma_f32_16x16x32_bf16 v[164:167], a[172:175], a[44:47], v[164:167]
    v_mfma_f32_16x16x32_bf16 v[164:167], a[176:179], a[48:51], v[164:167]
    v_mfma_f32_16x16x32_bf16 v[164:167], a[180:183], a[52:55], v[164:167]
    v_mfma_f32_16x16x32_bf16 v[164:167], a[184:187], a[56:59], v[164:167]
    v_mfma_f32_16x16x32_bf16 v[164:167], a[188:191], a[60:63], v[164:167]
    v_mfma_f32_16x16x32_bf16 v[168:171], a[160:163], a[64:67], 0
    v_mfma_f32_16x16x32_bf16 v[168:171], a[164:167], a[68:71], v[168:171]
    v_mfma_f32_16x16x32_bf16 v[168:171], a[168:171], a[72:75], v[168:171]
    v_mfma_f32_16x16x32_bf16 v[168:171], a[172:175], a[76:79], v[168:171]
    v_mfma_f32_16x16x32_bf16 v[168:171], a[176:179], a[80:83], v[168:171]
    v_mfma_f32_16x16x32_bf16 v[168:171], a[180:183], a[84:87], v[168:171]
    v_mfma_f32_16x16x32_bf16 v[168:171], a[184:187], a[88:91], v[168:171]
    v_mfma_f32_16x16x32_bf16 v[168:171], a[188:191], a[92:95], v[168:171]
    v_mfma_f32_16x16x32_bf16 v[172:175], a[160:163], a[96:99], 0
    v_mfma_f32_16x16x32_bf16 v[172:175], a[164:167], a[100:103], v[172:175]
    v_mfma_f32_16x16x32_bf16 v[172:175], a[168:171], a[104:107], v[172:175]
    v_mfma_f32_16x16x32_bf16 v[172:175], a[172:175], a[108:111], v[172:175]
    v_mfma_f32_16x16x32_bf16 v[172:175], a[176:179], a[112:115], v[172:175]
    v_mfma_f32_16x16x32_bf16 v[172:175], a[180:183], a[116:119], v[172:175]
    v_mfma_f32_16x16x32_bf16 v[172:175], a[184:187], a[120:123], v[172:175]
    v_mfma_f32_16x16x32_bf16 v[172:175], a[188:191], a[124:127], v[172:175]
    s_nop 7
    s_waitcnt vmcnt(12) lgkmcnt(0)
    s_barrier
    ds_read_b128 a[160:163], v214 offset:16384
    ds_read_b128 a[164:167], v215 offset:16384
    ds_read_b128 a[168:171], v216 offset:16384
    ds_read_b128 a[172:175], v217 offset:16384
    ds_read_b128 a[176:179], v214 offset:16640
    ds_read_b128 a[180:183], v215 offset:16640
    ds_read_b128 a[184:187], v216 offset:16640
    ds_read_b128 a[188:191], v217 offset:16640
    v_fma_f32 v160, v160, s24, -v209
    v_fma_f32 v161, v161, s24, -v209
    v_fma_f32 v162, v162, s24, -v209
    v_fma_f32 v163, v163, s24, -v209
    v_exp_f32 v160, v160
    v_exp_f32 v161, v161
    v_exp_f32 v162, v162
    v_exp_f32 v163, v163
    s_nop 0
    v_cvt_pk_bf16_f32 v200, v160, v161
    v_cvt_pk_bf16_f32 v201, v162, v163
    v_add_f32 v204, v204, v160
    v_add_f32 v204, v204, v161
    v_add_f32 v204, v204, v162
    v_add_f32 v204, v204, v163
    ds_write_b64 v226, v[200:201] offset:0
    v_fma_f32 v164, v164, s24, -v210
    v_fma_f32 v165, v165, s24, -v210
    v_fma_f32 v166, v166, s24, -v210
    v_fma_f32 v167, v167, s24, -v210
    v_exp_f32 v164, v164
    v_exp_f32 v165, v165
    v_exp_f32 v166, v166
    v_exp_f32 v167, v167
    s_nop 0
    v_cvt_pk_bf16_f32 v202, v164, v165
    v_cvt_pk_bf16_f32 v203, v166, v167
    v_add_f32 v205, v205, v164
    v_add_f32 v205, v205, v165
    v_add_f32 v205, v205, v166
    v_add_f32 v205, v205, v167
    ds_write_b64 v226, v[202:203] offset:1024
    v_fma_f32 v168, v168, s24, -v211
    v_fma_f32 v169, v169, s24, -v211
    v_fma_f32 v170, v170, s24, -v211
    v_fma_f32 v171, v171, s24, -v211
    v_exp_f32 v168, v168
    v_exp_f32 v169, v169
    v_exp_f32 v170, v170
    v_exp_f32 v171, v171
    s_nop 0
    v_cvt_pk_bf16_f32 v200, v168, v169
    v_cvt_pk_bf16_f32 v201, v170, v171
    v_add_f32 v206, v206, v168
    v_add_f32 v206, v206, v169
    v_add_f32 v206, v206, v170
    v_add_f32 v206, v206, v171
    ds_write_b64 v226, v[200:201] offset:2048
    v_fma_f32 v172, v172, s24, -v212
    v_fma_f32 v173, v173, s24, -v212
    v_fma_f32 v174, v174, s24, -v212
    v_fma_f32 v175, v175, s24, -v212
    v_exp_f32 v172, v172
    v_exp_f32 v173, v173
    s_waitcnt lgkmcnt(0)
    s_branch L_main_n4
L_done:
    s_endpgm
L_codeend:
.section .rodata,"a"
.p2align 6
.amdhsa_kernel standalone__mha_softmax__near_ridge_kernel
  .amdhsa_next_free_vgpr 512
  .amdhsa_next_free_sgpr 64
  .amdhsa_accum_offset 256
  .amdhsa_group_segment_fixed_size 0
  .amdhsa_kernarg_size 48
  .amdhsa_user_sgpr_count 2
  .amdhsa_user_sgpr_kernarg_segment_ptr 1
  .amdhsa_system_sgpr_workgroup_id_x 1
.end_amdhsa_kernel
```
